```python
import torch

def _softmax(x, axis=-1):
    return torch.softmax(x, dim=axis)

def _gelu(x):
    return torch.nn.functional.gelu(x, approximate='tanh')

def _silu(x):
    return torch.nn.functional.silu(x)

def _sigmoid(x):
    return torch.sigmoid(x)

def _layernorm(x, axis=-1, eps=1e-05):
    m = x.mean(dim=axis, keepdim=True)
    v = x.var(dim=axis, keepdim=True, unbiased=False)
    return (x - m) / torch.sqrt(v + eps)

def _scatter_add(tgt, idx, src, axis=0):
    return tgt.clone().index_add_(axis, idx, src)

def _segment_sum(src, seg, n):
    out = torch.zeros((n,) + src.shape[1:], dtype=src.dtype)
    return out.index_add_(0, seg, src)

def _pad(x, pw):
    flat = tuple((v for pair in reversed(pw) for v in pair))
    return torch.nn.functional.pad(x, flat)
kernel_name = 'standalone__autoregressive_conv_wavenet__speech'

def setup_inputs():

    _w = lambda a: (lambda t: t.to(torch.bfloat16) if t.is_floating_point() else t)(torch.as_tensor(a))
    B, T, D, K = (2, 16000, 144, 31)
    return {'x': _w((lambda *s: torch.randn(*s, dtype=torch.bfloat16) * 0.1)(B, T, D)), 'w': _w((lambda *s: torch.randn(*s, dtype=torch.bfloat16) * 0.1)(K, D, 2 * D)), 'w_o': _w((lambda *s: torch.randn(*s, dtype=torch.bfloat16) * 0.05)(D, D))}

def reference(x, w, w_o):
    B, T, D = x.shape
    K = w.shape[0]
    dil = 2
    pad = (K - 1) * dil
    xp = _pad(x, ((0, 0), (pad, 0), (0, 0)))
    h = torch.einsum('btc,cd->btd', xp[:, pad:pad + T, :], w[0])
    for i in range(1, K):
        off = pad - i * dil
        h = h + torch.einsum('btc,cd->btd', xp[:, off:off + T, :], w[i])
    f = h[..., :D].clone()
    g = h[..., D:].clone()
    z = torch.tanh(f) * _sigmoid(g)
    return z @ w_o
```

```asm
; @launch grid=(252,1,1) block=(512,1,1) lds=159744
.amdgcn_target "amdgcn-amd-amdhsa--gfx950"
.text
.globl standalone__autoregressive_conv_wavenet__speech_kernel
.p2align 8
.type standalone__autoregressive_conv_wavenet__speech_kernel,@function
standalone__autoregressive_conv_wavenet__speech_kernel:
    s_cmp_ge_u32 s2, 252
    s_cbranch_scc1 L_end
    s_load_dwordx4 s[4:7], s[0:1], 0
    s_load_dwordx2 s[8:9], s[0:1], 16
    s_load_dwordx4 s[56:59], s[0:1], 32
    v_lshrrev_b32 v1, 6, v0
    v_and_b32 v2, 63, v0
    v_readfirstlane_b32 s26, v1
    s_getpc_b64 s[44:45]
L_pc:
    s_lshl_b32 s42, s2, 8
    s_and_b32 s42, s42, 0x7800
    v_lshlrev_b32 v102, 4, v0
    v_lshrrev_b32 v103, 1, v1
    v_lshl_add_u32 v102, v103, 20, v102
    s_and_b32 s45, s45, 0xffff
    s_mov_b32 s46, L_end-L_pc
    s_mov_b32 s47, 0x00020000
    buffer_load_dwordx4 v[180:183], v102, s[44:47], s42 offen
    s_lshr_b32 s28, s26, 1
    s_cmp_eq_u32 s28, 2
    s_cbranch_scc1 Lp_w
    s_sub_u32 s27, s26, 2
    s_cmp_lt_u32 s26, 4
    s_cselect_b32 s27, s26, s27
    s_cmp_ge_u32 s2, 250
    s_cbranch_scc1 Lp_zero
    s_cmp_ge_u32 s2, 125
    s_cselect_b32 s24, 4608000, 0
    s_mul_i32 s28, s2, 36864
    s_sub_u32 s28, s28, s24
    s_sub_u32 s28, s28, 1792
    s_lshl_b32 s29, s27, 10
    s_add_u32 s28, s28, s29
    v_lshlrev_b32 v6, 4, v2
    v_add_u32 v6, s28, v6
    s_mov_b32 s14, 4608000
    s_mov_b32 s15, 0x00020000
    s_add_u32 m0, s29, 114688
    s_waitcnt lgkmcnt(0)
    s_add_u32 s12, s4, s24
    s_addc_u32 s13, s5, 0
    s_and_b32 s13, s13, 0xffff
    s_cmp_ge_u32 s26, 4
    s_cbranch_scc1 Lp_wpf
    buffer_load_dwordx4 v6, s[12:15], 0 offen lds
    s_add_u32 m0, s29, 118784
    v_add_u32 v6, 4096, v6
    buffer_load_dwordx4 v6, s[12:15], 0 offen lds
    s_add_u32 m0, s29, 122880
    v_add_u32 v6, 4096, v6
    buffer_load_dwordx4 v6, s[12:15], 0 offen lds
    s_add_u32 m0, s29, 126976
    v_add_u32 v6, 4096, v6
    buffer_load_dwordx4 v6, s[12:15], 0 offen lds
    s_add_u32 m0, s29, 131072
    v_add_u32 v6, 4096, v6
    buffer_load_dwordx4 v6, s[12:15], 0 offen lds
    s_add_u32 m0, s29, 135168
    v_add_u32 v6, 4096, v6
    buffer_load_dwordx4 v6, s[12:15], 0 offen lds
    s_add_u32 m0, s29, 139264
    v_add_u32 v6, 4096, v6
    buffer_load_dwordx4 v6, s[12:15], 0 offen lds
    s_add_u32 m0, s29, 143360
    v_add_u32 v6, 4096, v6
    buffer_load_dwordx4 v6, s[12:15], 0 offen lds
    s_add_u32 m0, s29, 147456
    v_add_u32 v6, 4096, v6
    buffer_load_dwordx4 v6, s[12:15], 0 offen lds
    s_add_u32 m0, s29, 151552
    v_add_u32 v6, 4096, v6
    s_cmp_ge_u32 s27, 2
    s_cbranch_scc1 Lp_xl
    buffer_load_dwordx4 v6, s[12:15], 0 offen lds
    s_branch Lp_xl
Lp_wpf:
    s_and_b32 s28, s2, 7
    s_mul_i32 s28, s28, 331776
    s_lshr_b32 s29, s2, 3
    s_lshl_b32 s29, s29, 1
    s_add_u32 s29, s29, s26
    s_sub_u32 s29, s29, 6
    s_mul_i32 s29, s29, 5248
    s_add_u32 s28, s28, s29
    s_mov_b32 s12, s6
    s_and_b32 s13, s7, 0xffff
    s_mov_b32 s14, 2571264
    s_mov_b32 s15, 0x00020000
    v_lshlrev_b32 v6, 4, v2
    v_add_u32 v7, 4096, v6
    buffer_load_dwordx4 v[184:187], v6, s[12:15], s28 offen offset:0
    buffer_load_dwordx4 v[188:191], v6, s[12:15], s28 offen offset:1024
    buffer_load_dwordx4 v[192:195], v6, s[12:15], s28 offen offset:2048
    buffer_load_dwordx4 v[196:199], v6, s[12:15], s28 offen offset:3072
    buffer_load_dwordx4 v[200:203], v7, s[12:15], s28 offen
    s_mov_b64 exec, 0xff
    buffer_load_dwordx4 v[204:207], v7, s[12:15], s28 offen offset:1024
    s_mov_b64 exec, -1
Lp_xl:
    s_mov_b32 s20, s58
    s_and_b32 s21, s59, 0xffff
    s_mov_b32 s22, 30497792
    s_mov_b32 s23, 0x00020000
    s_mov_b32 s16, s56
    s_and_b32 s17, s57, 0xffff
    s_mov_b32 s18, 256
    s_mov_b32 s19, 0x00020000
    s_mov_b32 s33, 0xffff0000
    v_mov_b32 v37, 0
    v_mov_b32 v32, 2130706432
    v_mov_b32 v33, 2130706432
    v_mov_b32 v34, 2130706432
    v_mov_b32 v35, 2130706432
    s_mov_b32 s96, 585216
    s_mov_b32 s97, 585216
    s_mov_b32 s98, 585216
    s_mov_b32 s99, 585216
    s_mov_b32 s31, 0
    s_mov_b32 s92, 0
    s_mov_b32 s93, 0
    s_cmp_ge_u32 s2, 125
    s_cselect_b32 s50, 8001024, 0
    s_mul_i32 s51, s2, 1536
    s_add_u32 s50, s50, 768
    s_add_u32 s50, s50, s51
    s_add_u32 s51, s50, 585216
    s_mov_b32 s35, 114752
    s_lshl_b32 s28, s2, 3
    s_add_u32 s28, s28, s26
    s_cmp_lg_u32 s28, 6
    s_cbranch_scc1 Lp_x0
    s_memrealtime s[92:93]
    s_waitcnt lgkmcnt(0)
    s_or_b32 s92, s92, 1
    v_mov_b32 v38, s92
    v_mov_b32 v39, s93
    s_mov_b64 exec, 1
    buffer_store_dwordx2 v[38:39], v37, s[16:19], 0 offen sc1
    s_mov_b64 exec, -1
Lp_x0:
    s_lshl_b32 s28, s26, 2
    s_lshr_b32 s30, 0x76002048, s28
    s_and_b32 s30, s30, 15
    s_lshl_b32 s28, s30, 6
    v_add_u32 v3, s28, v2
    v_mul_u32_u24 v4, 683, v3
    v_lshrrev_b32 v4, 16, v4
    v_mul_u32_u24 v5, 96, v4
    v_sub_u32 v3, v3, v5
    v_mul_u32_u24 v6, 43, v3
    v_lshrrev_b32 v6, 8, v6
    v_mul_u32_u24 v6, 2208, v6
    v_lshl_add_u32 v6, v3, 4, v6
    v_add3_u32 v6, v6, v5, s35
    v_cmp_le_u32 vcc, 3, v4
    v_mul_u32_u24 v7, 195072, v4
    v_mov_b32 v5, 3511296
    v_lshl_add_u32 v7, v3, 4, v7
    v_cndmask_b32 v5, 0, v5, vcc
    v_add_u32 v7, v7, v5
    s_bitcmp1_b32 0x0e, s26
    s_addc_u32 s30, s30, 0
    s_lshl_b32 s28, s30, 6
    v_add_u32 v3, s28, v2
    v_mul_u32_u24 v4, 683, v3
    v_lshrrev_b32 v4, 16, v4
    v_mul_u32_u24 v5, 96, v4
    v_sub_u32 v3, v3, v5
    v_mul_u32_u24 v14, 43, v3
    v_lshrrev_b32 v14, 8, v14
    v_mul_u32_u24 v14, 2208, v14
    v_lshl_add_u32 v14, v3, 4, v14
    v_add3_u32 v14, v14, v5, s35
    v_cmp_le_u32 vcc, 3, v4
    v_mul_u32_u24 v15, 195072, v4
    v_mov_b32 v5, 3511296
    v_lshl_add_u32 v15, v3, 4, v15
    v_cndmask_b32 v5, 0, v5, vcc
    v_add_u32 v15, v15, v5
    s_mov_b32 s44, 0x40109024
    s_mov_b32 s45, 0x40109024
    s_mov_b32 s46, 0xc078a000
    s_mov_b32 s47, 0xc078a000
    s_mov_b32 s48, 0x3e900000
    s_mov_b32 s49, 0x3e900000
    s_waitcnt vmcnt(0)
    s_barrier
    s_cmp_lg_u32 s26, 0
    s_cbranch_scc1 Lp_x1
    buffer_load_dwordx2 v[24:25], v37, s[16:19], 0 offen sc1
Lp_x1:
    ds_read_b128 v[120:123], v6 offset:3456
    ds_read_b128 v[124:127], v6 offset:2880
    ds_read_b128 v[128:131], v6 offset:2304
    ds_read_b128 v[132:135], v6 offset:1728
    ds_read_b128 v[136:139], v6 offset:1152
    ds_read_b128 v[140:143], v6 offset:576
    s_waitcnt lgkmcnt(5)
    v_lshlrev_b32 v148, 16, v120
    v_and_b32 v149, s33, v120
    s_waitcnt lgkmcnt(4)
    v_lshlrev_b32 v150, 16, v124
    v_and_b32 v151, s33, v124
    s_waitcnt lgkmcnt(3)
    v_lshlrev_b32 v152, 16, v128
    v_and_b32 v153, s33, v128
    s_waitcnt lgkmcnt(2)
    v_lshlrev_b32 v154, 16, v132
    v_and_b32 v155, s33, v132
    s_waitcnt lgkmcnt(1)
    v_lshlrev_b32 v156, 16, v136
    v_and_b32 v157, s33, v136
    s_waitcnt lgkmcnt(0)
    v_lshlrev_b32 v158, 16, v140
    v_and_b32 v159, s33, v140
    v_pk_fma_f32 v[162:163], s[46:47], v[152:153], v[156:157]
    v_pk_fma_f32 v[164:165], s[46:47], v[154:155], v[158:159]
    v_pk_fma_f32 v[162:163], s[44:45], v[148:149], v[162:163]
    v_pk_fma_f32 v[164:165], s[44:45], v[150:151], v[164:165]
    v_pk_fma_f32 v[166:167], s[48:49], v[162:163], v[164:165]
    v_pk_fma_f32 v[168:169], s[48:49], v[162:163], v[164:165] neg_lo:[0,1,0] neg_hi:[0,1,0]
    v_cvt_pk_bf16_f32 v172, v166, v167
    v_cvt_pk_bf16_f32 v176, v168, v169
    v_lshlrev_b32 v148, 16, v121
    v_and_b32 v149, s33, v121
    v_lshlrev_b32 v150, 16, v125
    v_and_b32 v151, s33, v125
    v_lshlrev_b32 v152, 16, v129
    v_and_b32 v153, s33, v129
    v_lshlrev_b32 v154, 16, v133
    v_and_b32 v155, s33, v133
    v_lshlrev_b32 v156, 16, v137
    v_and_b32 v157, s33, v137
    v_lshlrev_b32 v158, 16, v141
    v_and_b32 v159, s33, v141
    v_pk_fma_f32 v[162:163], s[46:47], v[152:153], v[156:157]
    v_pk_fma_f32 v[164:165], s[46:47], v[154:155], v[158:159]
    v_pk_fma_f32 v[162:163], s[44:45], v[148:149], v[162:163]
    v_pk_fma_f32 v[164:165], s[44:45], v[150:151], v[164:165]
    v_pk_fma_f32 v[166:167], s[48:49], v[162:163], v[164:165]
    v_pk_fma_f32 v[168:169], s[48:49], v[162:163], v[164:165] neg_lo:[0,1,0] neg_hi:[0,1,0]
    v_cvt_pk_bf16_f32 v173, v166, v167
    v_cvt_pk_bf16_f32 v177, v168, v169
    v_lshlrev_b32 v148, 16, v122
    v_and_b32 v149, s33, v122
    v_lshlrev_b32 v150, 16, v126
    v_and_b32 v151, s33, v126
    v_lshlrev_b32 v152, 16, v130
    v_and_b32 v153, s33, v130
    v_lshlrev_b32 v154, 16, v134
    v_and_b32 v155, s33, v134
    v_lshlrev_b32 v156, 16, v138
    v_and_b32 v157, s33, v138
    v_lshlrev_b32 v158, 16, v142
    v_and_b32 v159, s33, v142
    v_pk_fma_f32 v[162:163], s[46:47], v[152:153], v[156:157]
    v_pk_fma_f32 v[164:165], s[46:47], v[154:155], v[158:159]
    v_pk_fma_f32 v[162:163], s[44:45], v[148:149], v[162:163]
    v_pk_fma_f32 v[164:165], s[44:45], v[150:151], v[164:165]
    v_pk_fma_f32 v[166:167], s[48:49], v[162:163], v[164:165]
    v_pk_fma_f32 v[168:169], s[48:49], v[162:163], v[164:165] neg_lo:[0,1,0] neg_hi:[0,1,0]
    v_cvt_pk_bf16_f32 v174, v166, v167
    v_cvt_pk_bf16_f32 v178, v168, v169
    v_lshlrev_b32 v148, 16, v123
    v_and_b32 v149, s33, v123
    v_lshlrev_b32 v150, 16, v127
    v_and_b32 v151, s33, v127
    v_lshlrev_b32 v152, 16, v131
    v_and_b32 v153, s33, v131
    v_lshlrev_b32 v154, 16, v135
    v_and_b32 v155, s33, v135
    v_lshlrev_b32 v156, 16, v139
    v_and_b32 v157, s33, v139
    v_lshlrev_b32 v158, 16, v143
    v_and_b32 v159, s33, v143
    v_pk_fma_f32 v[162:163], s[46:47], v[152:153], v[156:157]
    v_pk_fma_f32 v[164:165], s[46:47], v[154:155], v[158:159]
    v_pk_fma_f32 v[162:163], s[44:45], v[148:149], v[162:163]
    v_pk_fma_f32 v[164:165], s[44:45], v[150:151], v[164:165]
    v_pk_fma_f32 v[166:167], s[48:49], v[162:163], v[164:165]
    v_pk_fma_f32 v[168:169], s[48:49], v[162:163], v[164:165] neg_lo:[0,1,0] neg_hi:[0,1,0]
    v_cvt_pk_bf16_f32 v175, v166, v167
    v_cvt_pk_bf16_f32 v179, v168, v169
    buffer_store_dwordx4 v[172:175], v7, s[20:23], s50 offen sc1
    buffer_store_dwordx4 v[176:179], v7, s[20:23], s51 offen sc1
    s_bitcmp1_b32 0x0e, s26
    s_cbranch_scc0 Lp_x2
    ds_read_b128 v[120:123], v14 offset:3456
    ds_read_b128 v[124:127], v14 offset:2880
    ds_read_b128 v[128:131], v14 offset:2304
    ds_read_b128 v[132:135], v14 offset:1728
    ds_read_b128 v[136:139], v14 offset:1152
    ds_read_b128 v[140:143], v14 offset:576
    s_waitcnt lgkmcnt(5)
    v_lshlrev_b32 v148, 16, v120
    v_and_b32 v149, s33, v120
    s_waitcnt lgkmcnt(4)
    v_lshlrev_b32 v150, 16, v124
    v_and_b32 v151, s33, v124
    s_waitcnt lgkmcnt(3)
    v_lshlrev_b32 v152, 16, v128
    v_and_b32 v153, s33, v128
    s_waitcnt lgkmcnt(2)
    v_lshlrev_b32 v154, 16, v132
    v_and_b32 v155, s33, v132
    s_waitcnt lgkmcnt(1)
    v_lshlrev_b32 v156, 16, v136
    v_and_b32 v157, s33, v136
    s_waitcnt lgkmcnt(0)
    v_lshlrev_b32 v158, 16, v140
    v_and_b32 v159, s33, v140
    v_pk_fma_f32 v[162:163], s[46:47], v[152:153], v[156:157]
    v_pk_fma_f32 v[164:165], s[46:47], v[154:155], v[158:159]
    v_pk_fma_f32 v[162:163], s[44:45], v[148:149], v[162:163]
    v_pk_fma_f32 v[164:165], s[44:45], v[150:151], v[164:165]
    v_pk_fma_f32 v[166:167], s[48:49], v[162:163], v[164:165]
    v_pk_fma_f32 v[168:169], s[48:49], v[162:163], v[164:165] neg_lo:[0,1,0] neg_hi:[0,1,0]
    v_cvt_pk_bf16_f32 v172, v166, v167
    v_cvt_pk_bf16_f32 v176, v168, v169
    v_lshlrev_b32 v148, 16, v121
    v_and_b32 v149, s33, v121
    v_lshlrev_b32 v150, 16, v125
    v_and_b32 v151, s33, v125
    v_lshlrev_b32 v152, 16, v129
    v_and_b32 v153, s33, v129
    v_lshlrev_b32 v154, 16, v133
    v_and_b32 v155, s33, v133
    v_lshlrev_b32 v156, 16, v137
    v_and_b32 v157, s33, v137
    v_lshlrev_b32 v158, 16, v141
    v_and_b32 v159, s33, v141
    v_pk_fma_f32 v[162:163], s[46:47], v[152:153], v[156:157]
    v_pk_fma_f32 v[164:165], s[46:47], v[154:155], v[158:159]
    v_pk_fma_f32 v[162:163], s[44:45], v[148:149], v[162:163]
    v_pk_fma_f32 v[164:165], s[44:45], v[150:151], v[164:165]
    v_pk_fma_f32 v[166:167], s[48:49], v[162:163], v[164:165]
    v_pk_fma_f32 v[168:169], s[48:49], v[162:163], v[164:165] neg_lo:[0,1,0] neg_hi:[0,1,0]
    v_cvt_pk_bf16_f32 v173, v166, v167
    v_cvt_pk_bf16_f32 v177, v168, v169
    v_lshlrev_b32 v148, 16, v122
    v_and_b32 v149, s33, v122
    v_lshlrev_b32 v150, 16, v126
    v_and_b32 v151, s33, v126
    v_lshlrev_b32 v152, 16, v130
    v_and_b32 v153, s33, v130
    v_lshlrev_b32 v154, 16, v134
    v_and_b32 v155, s33, v134
    v_lshlrev_b32 v156, 16, v138
    v_and_b32 v157, s33, v138
    v_lshlrev_b32 v158, 16, v142
    v_and_b32 v159, s33, v142
    v_pk_fma_f32 v[162:163], s[46:47], v[152:153], v[156:157]
    v_pk_fma_f32 v[164:165], s[46:47], v[154:155], v[158:159]
    v_pk_fma_f32 v[162:163], s[44:45], v[148:149], v[162:163]
    v_pk_fma_f32 v[164:165], s[44:45], v[150:151], v[164:165]
    v_pk_fma_f32 v[166:167], s[48:49], v[162:163], v[164:165]
    v_pk_fma_f32 v[168:169], s[48:49], v[162:163], v[164:165] neg_lo:[0,1,0] neg_hi:[0,1,0]
    v_cvt_pk_bf16_f32 v174, v166, v167
    v_cvt_pk_bf16_f32 v178, v168, v169
    v_lshlrev_b32 v148, 16, v123
    v_and_b32 v149, s33, v123
    v_lshlrev_b32 v150, 16, v127
    v_and_b32 v151, s33, v127
    v_lshlrev_b32 v152, 16, v131
    v_and_b32 v153, s33, v131
    v_lshlrev_b32 v154, 16, v135
    v_and_b32 v155, s33, v135
    v_lshlrev_b32 v156, 16, v139
    v_and_b32 v157, s33, v139
    v_lshlrev_b32 v158, 16, v143
    v_and_b32 v159, s33, v143
    v_pk_fma_f32 v[162:163], s[46:47], v[152:153], v[156:157]
    v_pk_fma_f32 v[164:165], s[46:47], v[154:155], v[158:159]
    v_pk_fma_f32 v[162:163], s[44:45], v[148:149], v[162:163]
    v_pk_fma_f32 v[164:165], s[44:45], v[150:151], v[164:165]
    v_pk_fma_f32 v[166:167], s[48:49], v[162:163], v[164:165]
    v_pk_fma_f32 v[168:169], s[48:49], v[162:163], v[164:165] neg_lo:[0,1,0] neg_hi:[0,1,0]
    v_cvt_pk_bf16_f32 v175, v166, v167
    v_cvt_pk_bf16_f32 v179, v168, v169
    buffer_store_dwordx4 v[172:175], v15, s[20:23], s50 offen sc1
    buffer_store_dwordx4 v[176:179], v15, s[20:23], s51 offen sc1
Lp_x2:
    s_cmp_ge_u32 s26, 4
    s_cbranch_scc1 Lp_h67
Lp_s2:
    v_mul_u32_u24 v9, 4352, v2
    s_lshl_b32 s30, s2, 3
    s_add_u32 s30, s30, 30320640
    s_cmp_lg_u32 s26, 0
    s_cbranch_scc1 Lp_s2b
    s_cmp_ge_u32 s2, 250
    s_cbranch_scc1 L_taga
    s_waitcnt vmcnt(2)
    v_readfirstlane_b32 s92, v24
    v_readfirstlane_b32 s93, v25
    s_nop 3
    s_cmp_lg_u32 s92, 0
    s_cbranch_scc1 L_tagda
L_taga:
    buffer_load_dwordx2 v[24:25], v37, s[16:19], 0 offen sc1
    s_add_u32 s31, s31, 1
    s_cmp_gt_u32 s31, 400000
    s_cbranch_scc1 L_tagda
    s_waitcnt vmcnt(0)
    v_readfirstlane_b32 s92, v24
    v_readfirstlane_b32 s93, v25
    s_nop 3
    s_cmp_eq_u32 s92, 0
    s_cbranch_scc1 L_taga
L_tagda:
    v_mov_b32 v38, s92
    v_mov_b32 v39, s93
    v_mov_b32 v40, s92
    v_mov_b32 v41, s93
Lp_s2b:
    s_waitcnt vmcnt(0)
    s_barrier
    s_cmp_lg_u32 s26, 0
    s_cbranch_scc1 L_pdone
    s_mov_b64 exec, 1
    buffer_store_dwordx2 v[38:39], v9, s[20:23], s30 offen sc1
    s_mov_b64 exec, -1
    s_branch L_pdone
Lp_h67:
    s_mov_b32 s36, 0x3e808020
    s_mov_b32 s37, 0x3e808020
    s_mov_b32 s38, 0xc0502000
    s_mov_b32 s39, 0xc0502000
    s_mov_b32 s40, 0x3f580000
    s_mov_b32 s41, 0x3f580000
    s_mov_b32 s42, 0x3d66a900
    s_mov_b32 s43, 0x3d66a900
    s_mov_b32 s44, 0xbf4a8000
    s_mov_b32 s45, 0xbf4a8000
    s_mov_b32 s46, 0x3fe40000
    s_mov_b32 s47, 0x3fe40000
    s_mov_b32 s48, 0xbe36f66e
    s_mov_b32 s49, 0xbe36f66e
    s_mov_b32 s52, 0x40243acc
    s_mov_b32 s53, 0x40243acc
    s_mov_b32 s54, 0xc07db000
    s_mov_b32 s55, 0xc07db000
    s_add_u32 s34, s50, 1170432
    v_add_u32 v33, s34, v7
    ds_read_b128 v[120:123], v6 offset:3456
    ds_read_b128 v[124:127], v6 offset:2880
    ds_read_b128 v[128:131], v6 offset:2304
    ds_read_b128 v[132:135], v6 offset:1728
    ds_read_b128 v[136:139], v6 offset:1152
    ds_read_b128 v[140:143], v6 offset:576
    ds_read_b128 v[144:147], v6 offset:0
    s_waitcnt lgkmcnt(6)
    v_lshlrev_b32 v148, 16, v120
    v_and_b32 v149, s33, v120
    s_waitcnt lgkmcnt(5)
    v_lshlrev_b32 v150, 16, v124
    v_and_b32 v151, s33, v124
    s_waitcnt lgkmcnt(4)
    v_lshlrev_b32 v152, 16, v128
    v_and_b32 v153, s33, v128
    s_waitcnt lgkmcnt(3)
    v_lshlrev_b32 v154, 16, v132
    v_and_b32 v155, s33, v132
    s_waitcnt lgkmcnt(2)
    v_lshlrev_b32 v156, 16, v136
    v_and_b32 v157, s33, v136
    s_waitcnt lgkmcnt(1)
    v_lshlrev_b32 v158, 16, v140
    v_and_b32 v159, s33, v140
    s_waitcnt lgkmcnt(0)
    v_lshlrev_b32 v160, 16, v144
    v_and_b32 v161, s33, v144
    v_pk_fma_f32 v[162:163], s[38:39], v[152:153], v[156:157]
    v_pk_fma_f32 v[164:165], s[38:39], v[154:155], v[158:159]
    v_pk_fma_f32 v[162:163], s[36:37], v[148:149], v[162:163]
    v_pk_fma_f32 v[164:165], s[36:37], v[150:151], v[164:165]
    v_pk_fma_f32 v[166:167], s[40:41], v[162:163], v[164:165]
    v_pk_fma_f32 v[168:169], s[40:41], v[162:163], v[164:165] neg_lo:[0,1,0] neg_hi:[0,1,0]
    v_cvt_pk_bf16_f32 v188, v166, v167
    v_cvt_pk_bf16_f32 v204, v168, v169
    v_pk_fma_f32 v[162:163], s[44:45], v[152:153], v[156:157]
    v_pk_fma_f32 v[164:165], s[44:45], v[154:155], v[158:159]
    v_pk_fma_f32 v[162:163], s[42:43], v[148:149], v[162:163]
    v_pk_fma_f32 v[164:165], s[42:43], v[150:151], v[164:165]
    v_pk_fma_f32 v[166:167], s[46:47], v[162:163], v[164:165]
    v_pk_fma_f32 v[168:169], s[46:47], v[162:163], v[164:165] neg_lo:[0,1,0] neg_hi:[0,1,0]
    v_cvt_pk_bf16_f32 v220, v166, v167
    v_cvt_pk_bf16_f32 v236, v168, v169
    v_pk_fma_f32 v[162:163], s[54:55], v[156:157], v[160:161]
    v_pk_fma_f32 v[162:163], s[52:53], v[152:153], v[162:163]
    v_pk_fma_f32 v[162:163], s[48:49], v[148:149], v[162:163]
    v_cvt_pk_bf16_f32 v252, v162, v163
    v_lshlrev_b32 v148, 16, v121
    v_and_b32 v149, s33, v121
    v_lshlrev_b32 v150, 16, v125
    v_and_b32 v151, s33, v125
    v_lshlrev_b32 v152, 16, v129
    v_and_b32 v153, s33, v129
    v_lshlrev_b32 v154, 16, v133
    v_and_b32 v155, s33, v133
    v_lshlrev_b32 v156, 16, v137
    v_and_b32 v157, s33, v137
    v_lshlrev_b32 v158, 16, v141
    v_and_b32 v159, s33, v141
    v_lshlrev_b32 v160, 16, v145
    v_and_b32 v161, s33, v145
    v_pk_fma_f32 v[162:163], s[38:39], v[152:153], v[156:157]
    v_pk_fma_f32 v[164:165], s[38:39], v[154:155], v[158:159]
    v_pk_fma_f32 v[162:163], s[36:37], v[148:149], v[162:163]
    v_pk_fma_f32 v[164:165], s[36:37], v[150:151], v[164:165]
    v_pk_fma_f32 v[166:167], s[40:41], v[162:163], v[164:165]
    v_pk_fma_f32 v[168:169], s[40:41], v[162:163], v[164:165] neg_lo:[0,1,0] neg_hi:[0,1,0]
    v_cvt_pk_bf16_f32 v189, v166, v167
    v_cvt_pk_bf16_f32 v205, v168, v169
    v_pk_fma_f32 v[162:163], s[44:45], v[152:153], v[156:157]
    v_pk_fma_f32 v[164:165], s[44:45], v[154:155], v[158:159]
    v_pk_fma_f32 v[162:163], s[42:43], v[148:149], v[162:163]
    v_pk_fma_f32 v[164:165], s[42:43], v[150:151], v[164:165]
    v_pk_fma_f32 v[166:167], s[46:47], v[162:163], v[164:165]
    v_pk_fma_f32 v[168:169], s[46:47], v[162:163], v[164:165] neg_lo:[0,1,0] neg_hi:[0,1,0]
    v_cvt_pk_bf16_f32 v221, v166, v167
    v_cvt_pk_bf16_f32 v237, v168, v169
    v_pk_fma_f32 v[162:163], s[54:55], v[156:157], v[160:161]
    v_pk_fma_f32 v[162:163], s[52:53], v[152:153], v[162:163]
    v_pk_fma_f32 v[162:163], s[48:49], v[148:149], v[162:163]
    v_cvt_pk_bf16_f32 v253, v162, v163
    v_lshlrev_b32 v148, 16, v122
    v_and_b32 v149, s33, v122
    v_lshlrev_b32 v150, 16, v126
    v_and_b32 v151, s33, v126
    v_lshlrev_b32 v152, 16, v130
    v_and_b32 v153, s33, v130
    v_lshlrev_b32 v154, 16, v134
    v_and_b32 v155, s33, v134
    v_lshlrev_b32 v156, 16, v138
    v_and_b32 v157, s33, v138
    v_lshlrev_b32 v158, 16, v142
    v_and_b32 v159, s33, v142
    v_lshlrev_b32 v160, 16, v146
    v_and_b32 v161, s33, v146
    v_pk_fma_f32 v[162:163], s[38:39], v[152:153], v[156:157]
    v_pk_fma_f32 v[164:165], s[38:39], v[154:155], v[158:159]
    v_pk_fma_f32 v[162:163], s[36:37], v[148:149], v[162:163]
    v_pk_fma_f32 v[164:165], s[36:37], v[150:151], v[164:165]
    v_pk_fma_f32 v[166:167], s[40:41], v[162:163], v[164:165]
    v_pk_fma_f32 v[168:169], s[40:41], v[162:163], v[164:165] neg_lo:[0,1,0] neg_hi:[0,1,0]
    v_cvt_pk_bf16_f32 v190, v166, v167
    v_cvt_pk_bf16_f32 v206, v168, v169
    v_pk_fma_f32 v[162:163], s[44:45], v[152:153], v[156:157]
    v_pk_fma_f32 v[164:165], s[44:45], v[154:155], v[158:159]
    v_pk_fma_f32 v[162:163], s[42:43], v[148:149], v[162:163]
    v_pk_fma_f32 v[164:165], s[42:43], v[150:151], v[164:165]
    v_pk_fma_f32 v[166:167], s[46:47], v[162:163], v[164:165]
    v_pk_fma_f32 v[168:169], s[46:47], v[162:163], v[164:165] neg_lo:[0,1,0] neg_hi:[0,1,0]
    v_cvt_pk_bf16_f32 v222, v166, v167
    v_cvt_pk_bf16_f32 v238, v168, v169
    v_pk_fma_f32 v[162:163], s[54:55], v[156:157], v[160:161]
    v_pk_fma_f32 v[162:163], s[52:53], v[152:153], v[162:163]
    v_pk_fma_f32 v[162:163], s[48:49], v[148:149], v[162:163]
    v_cvt_pk_bf16_f32 v254, v162, v163
    v_lshlrev_b32 v148, 16, v123
    v_and_b32 v149, s33, v123
    v_lshlrev_b32 v150, 16, v127
    v_and_b32 v151, s33, v127
    v_lshlrev_b32 v152, 16, v131
    v_and_b32 v153, s33, v131
    v_lshlrev_b32 v154, 16, v135
    v_and_b32 v155, s33, v135
    v_lshlrev_b32 v156, 16, v139
    v_and_b32 v157, s33, v139
    v_lshlrev_b32 v158, 16, v143
    v_and_b32 v159, s33, v143
    v_lshlrev_b32 v160, 16, v147
    v_and_b32 v161, s33, v147
    v_pk_fma_f32 v[162:163], s[38:39], v[152:153], v[156:157]
    v_pk_fma_f32 v[164:165], s[38:39], v[154:155], v[158:159]
    v_pk_fma_f32 v[162:163], s[36:37], v[148:149], v[162:163]
    v_pk_fma_f32 v[164:165], s[36:37], v[150:151], v[164:165]
    v_pk_fma_f32 v[166:167], s[40:41], v[162:163], v[164:165]
    v_pk_fma_f32 v[168:169], s[40:41], v[162:163], v[164:165] neg_lo:[0,1,0] neg_hi:[0,1,0]
    v_cvt_pk_bf16_f32 v191, v166, v167
    v_cvt_pk_bf16_f32 v207, v168, v169
    v_pk_fma_f32 v[162:163], s[44:45], v[152:153], v[156:157]
    v_pk_fma_f32 v[164:165], s[44:45], v[154:155], v[158:159]
    v_pk_fma_f32 v[162:163], s[42:43], v[148:149], v[162:163]
    v_pk_fma_f32 v[164:165], s[42:43], v[150:151], v[164:165]
    v_pk_fma_f32 v[166:167], s[46:47], v[162:163], v[164:165]
    v_pk_fma_f32 v[168:169], s[46:47], v[162:163], v[164:165] neg_lo:[0,1,0] neg_hi:[0,1,0]
    v_cvt_pk_bf16_f32 v223, v166, v167
    v_cvt_pk_bf16_f32 v239, v168, v169
    v_pk_fma_f32 v[162:163], s[54:55], v[156:157], v[160:161]
    v_pk_fma_f32 v[162:163], s[52:53], v[152:153], v[162:163]
    v_pk_fma_f32 v[162:163], s[48:49], v[148:149], v[162:163]
    v_cvt_pk_bf16_f32 v255, v162, v163
    s_waitcnt vmcnt(0)
    s_barrier
    s_sub_u32 s30, s26, 6
    s_lshl_b32 s30, s30, 1
Lp_x23:
    s_lshl_b32 s28, s30, 6
    v_add_u32 v3, s28, v2
    v_mul_u32_u24 v4, 683, v3
    v_lshrrev_b32 v4, 16, v4
    v_mul_u32_u24 v5, 96, v4
    v_sub_u32 v3, v3, v5
    v_mul_u32_u24 v6, 43, v3
    v_lshrrev_b32 v6, 8, v6
    v_mul_u32_u24 v6, 2208, v6
    v_lshl_add_u32 v6, v3, 4, v6
    v_add3_u32 v6, v6, v5, s35
    v_cmp_le_u32 vcc, 3, v4
    v_mul_u32_u24 v7, 195072, v4
    v_mov_b32 v5, 3511296
    v_lshl_add_u32 v7, v3, 4, v7
    v_cndmask_b32 v5, 0, v5, vcc
    v_add_u32 v7, v7, v5
    v_add_u32 v34, s34, v7
    ds_read_b128 v[120:123], v6 offset:3456
    ds_read_b128 v[124:127], v6 offset:2880
    ds_read_b128 v[128:131], v6 offset:2304
    ds_read_b128 v[132:135], v6 offset:1728
    ds_read_b128 v[136:139], v6 offset:1152
    ds_read_b128 v[140:143], v6 offset:576
    ds_read_b128 v[144:147], v6 offset:0
    s_waitcnt lgkmcnt(6)
    v_lshlrev_b32 v148, 16, v120
    v_and_b32 v149, s33, v120
    s_waitcnt lgkmcnt(5)
    v_lshlrev_b32 v150, 16, v124
    v_and_b32 v151, s33, v124
    s_waitcnt lgkmcnt(4)
    v_lshlrev_b32 v152, 16, v128
    v_and_b32 v153, s33, v128
    s_waitcnt lgkmcnt(3)
    v_lshlrev_b32 v154, 16, v132
    v_and_b32 v155, s33, v132
    s_waitcnt lgkmcnt(2)
    v_lshlrev_b32 v156, 16, v136
    v_and_b32 v157, s33, v136
    s_waitcnt lgkmcnt(1)
    v_lshlrev_b32 v158, 16, v140
    v_and_b32 v159, s33, v140
    s_waitcnt lgkmcnt(0)
    v_lshlrev_b32 v160, 16, v144
    v_and_b32 v161, s33, v144
    v_pk_fma_f32 v[162:163], s[38:39], v[152:153], v[156:157]
    v_pk_fma_f32 v[164:165], s[38:39], v[154:155], v[158:159]
    v_pk_fma_f32 v[162:163], s[36:37], v[148:149], v[162:163]
    v_pk_fma_f32 v[164:165], s[36:37], v[150:151], v[164:165]
    v_pk_fma_f32 v[166:167], s[40:41], v[162:163], v[164:165]
    v_pk_fma_f32 v[168:169], s[40:41], v[162:163], v[164:165] neg_lo:[0,1,0] neg_hi:[0,1,0]
    v_cvt_pk_bf16_f32 v192, v166, v167
    v_cvt_pk_bf16_f32 v208, v168, v169
    v_pk_fma_f32 v[162:163], s[44:45], v[152:153], v[156:157]
    v_pk_fma_f32 v[164:165], s[44:45], v[154:155], v[158:159]
    v_pk_fma_f32 v[162:163], s[42:43], v[148:149], v[162:163]
    v_pk_fma_f32 v[164:165], s[42:43], v[150:151], v[164:165]
    v_pk_fma_f32 v[166:167], s[46:47], v[162:163], v[164:165]
    v_pk_fma_f32 v[168:169], s[46:47], v[162:163], v[164:165] neg_lo:[0,1,0] neg_hi:[0,1,0]
    v_cvt_pk_bf16_f32 v224, v166, v167
    v_cvt_pk_bf16_f32 v240, v168, v169
    v_pk_fma_f32 v[162:163], s[54:55], v[156:157], v[160:161]
    v_pk_fma_f32 v[162:163], s[52:53], v[152:153], v[162:163]
    v_pk_fma_f32 v[162:163], s[48:49], v[148:149], v[162:163]
    v_cvt_pk_bf16_f32 v16, v162, v163
    v_lshlrev_b32 v148, 16, v121
    v_and_b32 v149, s33, v121
    v_lshlrev_b32 v150, 16, v125
    v_and_b32 v151, s33, v125
    v_lshlrev_b32 v152, 16, v129
    v_and_b32 v153, s33, v129
    v_lshlrev_b32 v154, 16, v133
    v_and_b32 v155, s33, v133
    v_lshlrev_b32 v156, 16, v137
    v_and_b32 v157, s33, v137
    v_lshlrev_b32 v158, 16, v141
    v_and_b32 v159, s33, v141
    v_lshlrev_b32 v160, 16, v145
    v_and_b32 v161, s33, v145
    v_pk_fma_f32 v[162:163], s[38:39], v[152:153], v[156:157]
    v_pk_fma_f32 v[164:165], s[38:39], v[154:155], v[158:159]
    v_pk_fma_f32 v[162:163], s[36:37], v[148:149], v[162:163]
    v_pk_fma_f32 v[164:165], s[36:37], v[150:151], v[164:165]
    v_pk_fma_f32 v[166:167], s[40:41], v[162:163], v[164:165]
    v_pk_fma_f32 v[168:169], s[40:41], v[162:163], v[164:165] neg_lo:[0,1,0] neg_hi:[0,1,0]
    v_cvt_pk_bf16_f32 v193, v166, v167
    v_cvt_pk_bf16_f32 v209, v168, v169
    v_pk_fma_f32 v[162:163], s[44:45], v[152:153], v[156:157]
    v_pk_fma_f32 v[164:165], s[44:45], v[154:155], v[158:159]
    v_pk_fma_f32 v[162:163], s[42:43], v[148:149], v[162:163]
    v_pk_fma_f32 v[164:165], s[42:43], v[150:151], v[164:165]
    v_pk_fma_f32 v[166:167], s[46:47], v[162:163], v[164:165]
    v_pk_fma_f32 v[168:169], s[46:47], v[162:163], v[164:165] neg_lo:[0,1,0] neg_hi:[0,1,0]
    v_cvt_pk_bf16_f32 v225, v166, v167
    v_cvt_pk_bf16_f32 v241, v168, v169
    v_pk_fma_f32 v[162:163], s[54:55], v[156:157], v[160:161]
    v_pk_fma_f32 v[162:163], s[52:53], v[152:153], v[162:163]
    v_pk_fma_f32 v[162:163], s[48:49], v[148:149], v[162:163]
    v_cvt_pk_bf16_f32 v17, v162, v163
    v_lshlrev_b32 v148, 16, v122
    v_and_b32 v149, s33, v122
    v_lshlrev_b32 v150, 16, v126
    v_and_b32 v151, s33, v126
    v_lshlrev_b32 v152, 16, v130
    v_and_b32 v153, s33, v130
    v_lshlrev_b32 v154, 16, v134
    v_and_b32 v155, s33, v134
    v_lshlrev_b32 v156, 16, v138
    v_and_b32 v157, s33, v138
    v_lshlrev_b32 v158, 16, v142
    v_and_b32 v159, s33, v142
    v_lshlrev_b32 v160, 16, v146
    v_and_b32 v161, s33, v146
    v_pk_fma_f32 v[162:163], s[38:39], v[152:153], v[156:157]
    v_pk_fma_f32 v[164:165], s[38:39], v[154:155], v[158:159]
    v_pk_fma_f32 v[162:163], s[36:37], v[148:149], v[162:163]
    v_pk_fma_f32 v[164:165], s[36:37], v[150:151], v[164:165]
    v_pk_fma_f32 v[166:167], s[40:41], v[162:163], v[164:165]
    v_pk_fma_f32 v[168:169], s[40:41], v[162:163], v[164:165] neg_lo:[0,1,0] neg_hi:[0,1,0]
    v_cvt_pk_bf16_f32 v194, v166, v167
    v_cvt_pk_bf16_f32 v210, v168, v169
    v_pk_fma_f32 v[162:163], s[44:45], v[152:153], v[156:157]
    v_pk_fma_f32 v[164:165], s[44:45], v[154:155], v[158:159]
    v_pk_fma_f32 v[162:163], s[42:43], v[148:149], v[162:163]
    v_pk_fma_f32 v[164:165], s[42:43], v[150:151], v[164:165]
    v_pk_fma_f32 v[166:167], s[46:47], v[162:163], v[164:165]
    v_pk_fma_f32 v[168:169], s[46:47], v[162:163], v[164:165] neg_lo:[0,1,0] neg_hi:[0,1,0]
    v_cvt_pk_bf16_f32 v226, v166, v167
    v_cvt_pk_bf16_f32 v242, v168, v169
    v_pk_fma_f32 v[162:163], s[54:55], v[156:157], v[160:161]
    v_pk_fma_f32 v[162:163], s[52:53], v[152:153], v[162:163]
    v_pk_fma_f32 v[162:163], s[48:49], v[148:149], v[162:163]
    v_cvt_pk_bf16_f32 v18, v162, v163
    v_lshlrev_b32 v148, 16, v123
    v_and_b32 v149, s33, v123
    v_lshlrev_b32 v150, 16, v127
    v_and_b32 v151, s33, v127
    v_lshlrev_b32 v152, 16, v131
    v_and_b32 v153, s33, v131
    v_lshlrev_b32 v154, 16, v135
    v_and_b32 v155, s33, v135
    v_lshlrev_b32 v156, 16, v139
    v_and_b32 v157, s33, v139
    v_lshlrev_b32 v158, 16, v143
    v_and_b32 v159, s33, v143
    v_lshlrev_b32 v160, 16, v147
    v_and_b32 v161, s33, v147
    v_pk_fma_f32 v[162:163], s[38:39], v[152:153], v[156:157]
    v_pk_fma_f32 v[164:165], s[38:39], v[154:155], v[158:159]
    v_pk_fma_f32 v[162:163], s[36:37], v[148:149], v[162:163]
    v_pk_fma_f32 v[164:165], s[36:37], v[150:151], v[164:165]
    v_pk_fma_f32 v[166:167], s[40:41], v[162:163], v[164:165]
    v_pk_fma_f32 v[168:169], s[40:41], v[162:163], v[164:165] neg_lo:[0,1,0] neg_hi:[0,1,0]
    v_cvt_pk_bf16_f32 v195, v166, v167
    v_cvt_pk_bf16_f32 v211, v168, v169
    v_pk_fma_f32 v[162:163], s[44:45], v[152:153], v[156:157]
    v_pk_fma_f32 v[164:165], s[44:45], v[154:155], v[158:159]
    v_pk_fma_f32 v[162:163], s[42:43], v[148:149], v[162:163]
    v_pk_fma_f32 v[164:165], s[42:43], v[150:151], v[164:165]
    v_pk_fma_f32 v[166:167], s[46:47], v[162:163], v[164:165]
    v_pk_fma_f32 v[168:169], s[46:47], v[162:163], v[164:165] neg_lo:[0,1,0] neg_hi:[0,1,0]
    v_cvt_pk_bf16_f32 v227, v166, v167
    v_cvt_pk_bf16_f32 v243, v168, v169
    v_pk_fma_f32 v[162:163], s[54:55], v[156:157], v[160:161]
    v_pk_fma_f32 v[162:163], s[52:53], v[152:153], v[162:163]
    v_pk_fma_f32 v[162:163], s[48:49], v[148:149], v[162:163]
    v_cvt_pk_bf16_f32 v19, v162, v163
    s_add_u32 s30, s30, 1
Lp_x3:
    s_lshl_b32 s28, s30, 6
    v_add_u32 v3, s28, v2
    v_mul_u32_u24 v4, 683, v3
    v_lshrrev_b32 v4, 16, v4
    v_mul_u32_u24 v5, 96, v4
    v_sub_u32 v3, v3, v5
    v_mul_u32_u24 v6, 43, v3
    v_lshrrev_b32 v6, 8, v6
    v_mul_u32_u24 v6, 2208, v6
    v_lshl_add_u32 v6, v3, 4, v6
    v_add3_u32 v6, v6, v5, s35
    v_cmp_le_u32 vcc, 3, v4
    v_mul_u32_u24 v7, 195072, v4
    v_mov_b32 v5, 3511296
    v_lshl_add_u32 v7, v3, 4, v7
    v_cndmask_b32 v5, 0, v5, vcc
    v_add_u32 v7, v7, v5
    v_add_u32 v35, s34, v7
    ds_read_b128 v[120:123], v6 offset:3456
    ds_read_b128 v[124:127], v6 offset:2880
    ds_read_b128 v[128:131], v6 offset:2304
    ds_read_b128 v[132:135], v6 offset:1728
    ds_read_b128 v[136:139], v6 offset:1152
    ds_read_b128 v[140:143], v6 offset:576
    ds_read_b128 v[144:147], v6 offset:0
    s_waitcnt lgkmcnt(6)
    v_lshlrev_b32 v148, 16, v120
    v_and_b32 v149, s33, v120
    s_waitcnt lgkmcnt(5)
    v_lshlrev_b32 v150, 16, v124
    v_and_b32 v151, s33, v124
    s_waitcnt lgkmcnt(4)
    v_lshlrev_b32 v152, 16, v128
    v_and_b32 v153, s33, v128
    s_waitcnt lgkmcnt(3)
    v_lshlrev_b32 v154, 16, v132
    v_and_b32 v155, s33, v132
    s_waitcnt lgkmcnt(2)
    v_lshlrev_b32 v156, 16, v136
    v_and_b32 v157, s33, v136
    s_waitcnt lgkmcnt(1)
    v_lshlrev_b32 v158, 16, v140
    v_and_b32 v159, s33, v140
    s_waitcnt lgkmcnt(0)
    v_lshlrev_b32 v160, 16, v144
    v_and_b32 v161, s33, v144
    v_pk_fma_f32 v[162:163], s[38:39], v[152:153], v[156:157]
    v_pk_fma_f32 v[164:165], s[38:39], v[154:155], v[158:159]
    v_pk_fma_f32 v[162:163], s[36:37], v[148:149], v[162:163]
    v_pk_fma_f32 v[164:165], s[36:37], v[150:151], v[164:165]
    v_pk_fma_f32 v[166:167], s[40:41], v[162:163], v[164:165]
    v_pk_fma_f32 v[168:169], s[40:41], v[162:163], v[164:165] neg_lo:[0,1,0] neg_hi:[0,1,0]
    v_cvt_pk_bf16_f32 v196, v166, v167
    v_cvt_pk_bf16_f32 v212, v168, v169
    v_pk_fma_f32 v[162:163], s[44:45], v[152:153], v[156:157]
    v_pk_fma_f32 v[164:165], s[44:45], v[154:155], v[158:159]
    v_pk_fma_f32 v[162:163], s[42:43], v[148:149], v[162:163]
    v_pk_fma_f32 v[164:165], s[42:43], v[150:151], v[164:165]
    v_pk_fma_f32 v[166:167], s[46:47], v[162:163], v[164:165]
    v_pk_fma_f32 v[168:169], s[46:47], v[162:163], v[164:165] neg_lo:[0,1,0] neg_hi:[0,1,0]
    v_cvt_pk_bf16_f32 v228, v166, v167
    v_cvt_pk_bf16_f32 v244, v168, v169
    v_pk_fma_f32 v[162:163], s[54:55], v[156:157], v[160:161]
    v_pk_fma_f32 v[162:163], s[52:53], v[152:153], v[162:163]
    v_pk_fma_f32 v[162:163], s[48:49], v[148:149], v[162:163]
    v_cvt_pk_bf16_f32 v20, v162, v163
    v_lshlrev_b32 v148, 16, v121
    v_and_b32 v149, s33, v121
    v_lshlrev_b32 v150, 16, v125
    v_and_b32 v151, s33, v125
    v_lshlrev_b32 v152, 16, v129
    v_and_b32 v153, s33, v129
    v_lshlrev_b32 v154, 16, v133
    v_and_b32 v155, s33, v133
    v_lshlrev_b32 v156, 16, v137
    v_and_b32 v157, s33, v137
    v_lshlrev_b32 v158, 16, v141
    v_and_b32 v159, s33, v141
    v_lshlrev_b32 v160, 16, v145
    v_and_b32 v161, s33, v145
    v_pk_fma_f32 v[162:163], s[38:39], v[152:153], v[156:157]
    v_pk_fma_f32 v[164:165], s[38:39], v[154:155], v[158:159]
    v_pk_fma_f32 v[162:163], s[36:37], v[148:149], v[162:163]
    v_pk_fma_f32 v[164:165], s[36:37], v[150:151], v[164:165]
    v_pk_fma_f32 v[166:167], s[40:41], v[162:163], v[164:165]
    v_pk_fma_f32 v[168:169], s[40:41], v[162:163], v[164:165] neg_lo:[0,1,0] neg_hi:[0,1,0]
    v_cvt_pk_bf16_f32 v197, v166, v167
    v_cvt_pk_bf16_f32 v213, v168, v169
    v_pk_fma_f32 v[162:163], s[44:45], v[152:153], v[156:157]
    v_pk_fma_f32 v[164:165], s[44:45], v[154:155], v[158:159]
    v_pk_fma_f32 v[162:163], s[42:43], v[148:149], v[162:163]
    v_pk_fma_f32 v[164:165], s[42:43], v[150:151], v[164:165]
    v_pk_fma_f32 v[166:167], s[46:47], v[162:163], v[164:165]
    v_pk_fma_f32 v[168:169], s[46:47], v[162:163], v[164:165] neg_lo:[0,1,0] neg_hi:[0,1,0]
    v_cvt_pk_bf16_f32 v229, v166, v167
    v_cvt_pk_bf16_f32 v245, v168, v169
    v_pk_fma_f32 v[162:163], s[54:55], v[156:157], v[160:161]
    v_pk_fma_f32 v[162:163], s[52:53], v[152:153], v[162:163]
    v_pk_fma_f32 v[162:163], s[48:49], v[148:149], v[162:163]
    v_cvt_pk_bf16_f32 v21, v162, v163
    v_lshlrev_b32 v148, 16, v122
    v_and_b32 v149, s33, v122
    v_lshlrev_b32 v150, 16, v126
    v_and_b32 v151, s33, v126
    v_lshlrev_b32 v152, 16, v130
    v_and_b32 v153, s33, v130
    v_lshlrev_b32 v154, 16, v134
    v_and_b32 v155, s33, v134
    v_lshlrev_b32 v156, 16, v138
    v_and_b32 v157, s33, v138
    v_lshlrev_b32 v158, 16, v142
    v_and_b32 v159, s33, v142
    v_lshlrev_b32 v160, 16, v146
    v_and_b32 v161, s33, v146
    v_pk_fma_f32 v[162:163], s[38:39], v[152:153], v[156:157]
    v_pk_fma_f32 v[164:165], s[38:39], v[154:155], v[158:159]
    v_pk_fma_f32 v[162:163], s[36:37], v[148:149], v[162:163]
    v_pk_fma_f32 v[164:165], s[36:37], v[150:151], v[164:165]
    v_pk_fma_f32 v[166:167], s[40:41], v[162:163], v[164:165]
    v_pk_fma_f32 v[168:169], s[40:41], v[162:163], v[164:165] neg_lo:[0,1,0] neg_hi:[0,1,0]
    v_cvt_pk_bf16_f32 v198, v166, v167
    v_cvt_pk_bf16_f32 v214, v168, v169
    v_pk_fma_f32 v[162:163], s[44:45], v[152:153], v[156:157]
    v_pk_fma_f32 v[164:165], s[44:45], v[154:155], v[158:159]
    v_pk_fma_f32 v[162:163], s[42:43], v[148:149], v[162:163]
    v_pk_fma_f32 v[164:165], s[42:43], v[150:151], v[164:165]
    v_pk_fma_f32 v[166:167], s[46:47], v[162:163], v[164:165]
    v_pk_fma_f32 v[168:169], s[46:47], v[162:163], v[164:165] neg_lo:[0,1,0] neg_hi:[0,1,0]
    v_cvt_pk_bf16_f32 v230, v166, v167
    v_cvt_pk_bf16_f32 v246, v168, v169
    v_pk_fma_f32 v[162:163], s[54:55], v[156:157], v[160:161]
    v_pk_fma_f32 v[162:163], s[52:53], v[152:153], v[162:163]
    v_pk_fma_f32 v[162:163], s[48:49], v[148:149], v[162:163]
    v_cvt_pk_bf16_f32 v22, v162, v163
    v_lshlrev_b32 v148, 16, v123
    v_and_b32 v149, s33, v123
    v_lshlrev_b32 v150, 16, v127
    v_and_b32 v151, s33, v127
    v_lshlrev_b32 v152, 16, v131
    v_and_b32 v153, s33, v131
    v_lshlrev_b32 v154, 16, v135
    v_and_b32 v155, s33, v135
    v_lshlrev_b32 v156, 16, v139
    v_and_b32 v157, s33, v139
    v_lshlrev_b32 v158, 16, v143
    v_and_b32 v159, s33, v143
    v_lshlrev_b32 v160, 16, v147
    v_and_b32 v161, s33, v147
    v_pk_fma_f32 v[162:163], s[38:39], v[152:153], v[156:157]
    v_pk_fma_f32 v[164:165], s[38:39], v[154:155], v[158:159]
    v_pk_fma_f32 v[162:163], s[36:37], v[148:149], v[162:163]
    v_pk_fma_f32 v[164:165], s[36:37], v[150:151], v[164:165]
    v_pk_fma_f32 v[166:167], s[40:41], v[162:163], v[164:165]
    v_pk_fma_f32 v[168:169], s[40:41], v[162:163], v[164:165] neg_lo:[0,1,0] neg_hi:[0,1,0]
    v_cvt_pk_bf16_f32 v199, v166, v167
    v_cvt_pk_bf16_f32 v215, v168, v169
    v_pk_fma_f32 v[162:163], s[44:45], v[152:153], v[156:157]
    v_pk_fma_f32 v[164:165], s[44:45], v[154:155], v[158:159]
    v_pk_fma_f32 v[162:163], s[42:43], v[148:149], v[162:163]
    v_pk_fma_f32 v[164:165], s[42:43], v[150:151], v[164:165]
    v_pk_fma_f32 v[166:167], s[46:47], v[162:163], v[164:165]
    v_pk_fma_f32 v[168:169], s[46:47], v[162:163], v[164:165] neg_lo:[0,1,0] neg_hi:[0,1,0]
    v_cvt_pk_bf16_f32 v231, v166, v167
    v_cvt_pk_bf16_f32 v247, v168, v169
    v_pk_fma_f32 v[162:163], s[54:55], v[156:157], v[160:161]
    v_pk_fma_f32 v[162:163], s[52:53], v[152:153], v[162:163]
    v_pk_fma_f32 v[162:163], s[48:49], v[148:149], v[162:163]
    v_cvt_pk_bf16_f32 v23, v162, v163
    s_branch L_pdone
Lp_zero:
    s_waitcnt lgkmcnt(0)
    s_mov_b32 s20, s58
    s_and_b32 s21, s59, 0xffff
    s_mov_b32 s22, 30497792
    s_mov_b32 s23, 0x00020000
    s_mov_b32 s16, s56
    s_and_b32 s17, s57, 0xffff
    s_mov_b32 s18, 256
    s_mov_b32 s19, 0x00020000
    s_mov_b32 s33, 0xffff0000
    v_mov_b32 v37, 0
    v_mov_b32 v32, 2130706432
    v_mov_b32 v33, 2130706432
    v_mov_b32 v34, 2130706432
    v_mov_b32 v35, 2130706432
    s_mov_b32 s96, 585216
    s_mov_b32 s97, 585216
    s_mov_b32 s98, 585216
    s_mov_b32 s99, 585216
    s_mov_b32 s31, 0
    s_mov_b32 s92, 0
    s_mov_b32 s93, 0
    s_cmp_ge_u32 s2, 125
    s_cselect_b32 s50, 8001024, 0
    s_mul_i32 s51, s2, 1536
    s_add_u32 s50, s50, 768
    s_add_u32 s50, s50, s51
    s_add_u32 s51, s50, 585216
    s_mov_b32 s35, 114752
    s_sub_u32 s3, s2, 250
    s_mul_i32 s30, s3, 8193024
    s_lshl_b32 s28, s27, 6
    v_add_u32 v3, s28, v2
    v_mov_b32 v16, 0
    v_mov_b32 v17, 0
    v_mov_b32 v18, 0
    v_mov_b32 v19, 0
    v_mul_u32_u24 v4, 1366, v3
    v_lshrrev_b32 v4, 16, v4
    v_mul_u32_u24 v5, 48, v4
    v_sub_u32 v5, v3, v5
    v_mul_u32_u24 v4, 195072, v4
    v_lshl_add_u32 v4, v5, 4, v4
    v_cmp_gt_u32 vcc, 2016, v3
    v_mov_b32 v5, 2130706432
    v_add_u32 v3, 384, v3
    v_cndmask_b32 v4, v5, v4, vcc
    buffer_store_dwordx4 v[16:19], v4, s[20:23], s30 offen sc1
    v_mul_u32_u24 v4, 1366, v3
    v_lshrrev_b32 v4, 16, v4
    v_mul_u32_u24 v5, 48, v4
    v_sub_u32 v5, v3, v5
    v_mul_u32_u24 v4, 195072, v4
    v_lshl_add_u32 v4, v5, 4, v4
    v_cmp_gt_u32 vcc, 2016, v3
    v_mov_b32 v5, 2130706432
    v_add_u32 v3, 384, v3
    v_cndmask_b32 v4, v5, v4, vcc
    buffer_store_dwordx4 v[16:19], v4, s[20:23], s30 offen sc1
    v_mul_u32_u24 v4, 1366, v3
    v_lshrrev_b32 v4, 16, v4
    v_mul_u32_u24 v5, 48, v4
    v_sub_u32 v5, v3, v5
    v_mul_u32_u24 v4, 195072, v4
    v_lshl_add_u32 v4, v5, 4, v4
    v_cmp_gt_u32 vcc, 2016, v3
    v_mov_b32 v5, 2130706432
    v_add_u32 v3, 384, v3
    v_cndmask_b32 v4, v5, v4, vcc
    buffer_store_dwordx4 v[16:19], v4, s[20:23], s30 offen sc1
    v_mul_u32_u24 v4, 1366, v3
    v_lshrrev_b32 v4, 16, v4
    v_mul_u32_u24 v5, 48, v4
    v_sub_u32 v5, v3, v5
    v_mul_u32_u24 v4, 195072, v4
    v_lshl_add_u32 v4, v5, 4, v4
    v_cmp_gt_u32 vcc, 2016, v3
    v_mov_b32 v5, 2130706432
    v_add_u32 v3, 384, v3
    v_cndmask_b32 v4, v5, v4, vcc
    buffer_store_dwordx4 v[16:19], v4, s[20:23], s30 offen sc1
    v_mul_u32_u24 v4, 1366, v3
    v_lshrrev_b32 v4, 16, v4
    v_mul_u32_u24 v5, 48, v4
    v_sub_u32 v5, v3, v5
    v_mul_u32_u24 v4, 195072, v4
    v_lshl_add_u32 v4, v5, 4, v4
    v_cmp_gt_u32 vcc, 2016, v3
    v_mov_b32 v5, 2130706432
    v_add_u32 v3, 384, v3
    v_cndmask_b32 v4, v5, v4, vcc
    buffer_store_dwordx4 v[16:19], v4, s[20:23], s30 offen sc1
    v_mul_u32_u24 v4, 1366, v3
    v_lshrrev_b32 v4, 16, v4
    v_mul_u32_u24 v5, 48, v4
    v_sub_u32 v5, v3, v5
    v_mul_u32_u24 v4, 195072, v4
    v_lshl_add_u32 v4, v5, 4, v4
    v_cmp_gt_u32 vcc, 2016, v3
    v_mov_b32 v5, 2130706432
    v_add_u32 v3, 384, v3
    v_cndmask_b32 v4, v5, v4, vcc
    buffer_store_dwordx4 v[16:19], v4, s[20:23], s30 offen sc1
    s_barrier
    s_branch Lp_s2
Lp_w:
    s_and_b32 s27, s26, 1
    s_and_b32 s28, s2, 7
    s_lshr_b32 s29, s2, 3
    s_mul_i32 s3, s28, 40
    s_min_u32 s30, s28, 4
    s_add_u32 s3, s3, s30
    s_add_u32 s3, s3, s29
    s_min_u32 s30, s29, 9
    s_add_u32 s3, s3, s30
    s_add_u32 s3, s3, s27
    s_mul_i32 s30, s27, s29
    s_cmp_ge_u32 s30, 9
    s_cbranch_scc1 Lp_wo
    s_lshl_b32 s28, s3, 5
    v_and_b32 v3, 31, v2
    v_add_u32 v4, s28, v3
    v_mul_u32_u24 v5, 58255, v4
    v_lshrrev_b32 v5, 22, v5
    v_mul_u32_u24 v9, 72, v5
    v_sub_u32 v6, v4, v9
    v_mul_u32_u24 v7, 3641, v5
    v_lshrrev_b32 v7, 16, v7
    v_mul_u32_u24 v9, 18, v7
    v_sub_u32 v8, v5, v9
    v_mul_u32_u24 v7, 331776, v7
    v_mul_u32_u24 v8, 4608, v8
    v_lshrrev_b32 v9, 5, v2
    v_mul_u32_u24 v10, 288, v9
    v_add3_u32 v7, v7, v8, v10
    v_lshl_add_u32 v6, v6, 2, v7
    s_waitcnt lgkmcnt(0)
    s_mov_b32 s12, s6
    s_and_b32 s13, s7, 0xffff
    s_mov_b32 s14, 2571264
    s_mov_b32 s15, 0x00020000
    s_mov_b32 s37, 82944
    s_mov_b32 s38, 165888
    s_mov_b32 s39, 248832
    buffer_load_dword v41, v6, s[12:15], 0 offen offset:0
    buffer_load_dword v57, v6, s[12:15], s37 offen offset:0
    buffer_load_dword v73, v6, s[12:15], s38 offen offset:0
    buffer_load_dword v89, v6, s[12:15], s39 offen offset:0
    buffer_load_dword v43, v6, s[12:15], 0 offen offset:576
    buffer_load_dword v59, v6, s[12:15], s37 offen offset:576
    buffer_load_dword v75, v6, s[12:15], s38 offen offset:576
    buffer_load_dword v91, v6, s[12:15], s39 offen offset:576
    buffer_load_dword v45, v6, s[12:15], 0 offen offset:1152
    buffer_load_dword v61, v6, s[12:15], s37 offen offset:1152
    buffer_load_dword v77, v6, s[12:15], s38 offen offset:1152
    buffer_load_dword v93, v6, s[12:15], s39 offen offset:1152
    buffer_load_dword v47, v6, s[12:15], 0 offen offset:1728
    buffer_load_dword v63, v6, s[12:15], s37 offen offset:1728
    buffer_load_dword v79, v6, s[12:15], s38 offen offset:1728
    buffer_load_dword v95, v6, s[12:15], s39 offen offset:1728
    buffer_load_dword v49, v6, s[12:15], 0 offen offset:2304
    buffer_load_dword v65, v6, s[12:15], s37 offen offset:2304
    buffer_load_dword v81, v6, s[12:15], s38 offen offset:2304
    buffer_load_dword v97, v6, s[12:15], s39 offen offset:2304
    buffer_load_dword v51, v6, s[12:15], 0 offen offset:2880
    buffer_load_dword v67, v6, s[12:15], s37 offen offset:2880
    buffer_load_dword v83, v6, s[12:15], s38 offen offset:2880
    buffer_load_dword v99, v6, s[12:15], s39 offen offset:2880
    buffer_load_dword v53, v6, s[12:15], 0 offen offset:3456
    buffer_load_dword v69, v6, s[12:15], s37 offen offset:3456
    buffer_load_dword v85, v6, s[12:15], s38 offen offset:3456
    buffer_load_dword v101, v6, s[12:15], s39 offen offset:3456
    buffer_load_dword v55, v6, s[12:15], 0 offen offset:4032
    buffer_load_dword v71, v6, s[12:15], s37 offen offset:4032
    buffer_load_dword v87, v6, s[12:15], s38 offen offset:4032
    buffer_load_dword v103, v6, s[12:15], s39 offen offset:4032
    s_mov_b32 s20, s58
    s_and_b32 s21, s59, 0xffff
    s_mov_b32 s22, 30497792
    s_mov_b32 s23, 0x00020000
    s_mov_b32 s16, s56
    s_and_b32 s17, s57, 0xffff
    s_mov_b32 s18, 256
    s_mov_b32 s19, 0x00020000
    s_mov_b32 s33, 0xffff0000
    v_mov_b32 v37, 0
    v_mov_b32 v32, 2130706432
    v_mov_b32 v33, 2130706432
    v_mov_b32 v34, 2130706432
    v_mov_b32 v35, 2130706432
    s_mov_b32 s96, 585216
    s_mov_b32 s97, 585216
    s_mov_b32 s98, 585216
    s_mov_b32 s99, 585216
    s_mov_b32 s31, 0
    s_mov_b32 s92, 0
    s_mov_b32 s93, 0
    s_cmp_ge_u32 s2, 125
    s_cselect_b32 s50, 8001024, 0
    s_mul_i32 s51, s2, 1536
    s_add_u32 s50, s50, 768
    s_add_u32 s50, s50, s51
    s_add_u32 s51, s50, 585216
    s_mov_b32 s35, 114752
    s_lshl_b32 s29, s27, 14
    s_add_u32 s29, s29, 53248
    v_lshlrev_b32 v10, 6, v3
    v_lshl_add_u32 v10, v9, 5, v10
    v_add_u32 v10, s29, v10
    v_lshlrev_b32 v11, 4, v2
    v_add_u32 v11, s29, v11
    v_lshrrev_b32 v4, 2, v2
    v_add3_u32 v4, v4, s28, 0
    v_mul_u32_u24 v5, 58255, v4
    v_lshrrev_b32 v5, 22, v5
    v_mul_u32_u24 v9, 72, v5
    v_sub_u32 v6, v4, v9
    v_mul_u32_u24 v7, 3641, v5
    v_lshrrev_b32 v7, 16, v7
    v_mul_u32_u24 v9, 18, v7
    v_sub_u32 v8, v5, v9
    v_mul_u32_u24 v4, 43, v8
    v_lshrrev_b32 v4, 8, v4
    v_mul_u32_u24 v5, 6, v4
    v_sub_u32 v5, v8, v5
    v_lshrrev_b32 v8, 1, v7
    v_add_u32 v8, 8, v8
    v_and_b32 v9, 1, v7
    v_lshl_add_u32 v9, v9, 1, v5
    v_subrev_u32 v9, 4, v9
    v_cmp_le_u32 vcc, 4, v5
    v_mul_u32_u24 v4, 24576, v4
    v_lshrrev_b32 v14, 3, v6
    v_cndmask_b32 v8, v7, v8, vcc
    v_cndmask_b32 v9, v5, v9, vcc
    v_mul_u32_u24 v14, 516096, v14
    v_bfe_u32 v15, v6, 2, 1
    v_mul_u32_u24 v15, 12288, v15
    v_add3_u32 v12, v4, v14, v15
    v_lshl_add_u32 v12, v8, 10, v12
    v_lshl_add_u32 v12, v9, 8, v12
    v_and_b32 v4, 3, v6
    v_lshl_add_u32 v12, v4, 6, v12
    v_and_b32 v4, 3, v2
    v_lshl_add_u32 v12, v4, 4, v12
    v_lshrrev_b32 v4, 2, v2
    v_add3_u32 v4, v4, s28, 16
    v_mul_u32_u24 v5, 58255, v4
    v_lshrrev_b32 v5, 22, v5
    v_mul_u32_u24 v9, 72, v5
    v_sub_u32 v6, v4, v9
    v_mul_u32_u24 v7, 3641, v5
    v_lshrrev_b32 v7, 16, v7
    v_mul_u32_u24 v9, 18, v7
    v_sub_u32 v8, v5, v9
    v_mul_u32_u24 v4, 43, v8
    v_lshrrev_b32 v4, 8, v4
    v_mul_u32_u24 v5, 6, v4
    v_sub_u32 v5, v8, v5
    v_lshrrev_b32 v8, 1, v7
    v_add_u32 v8, 8, v8
    v_and_b32 v9, 1, v7
    v_lshl_add_u32 v9, v9, 1, v5
    v_subrev_u32 v9, 4, v9
    v_cmp_le_u32 vcc, 4, v5
    v_mul_u32_u24 v4, 24576, v4
    v_lshrrev_b32 v14, 3, v6
    v_cndmask_b32 v8, v7, v8, vcc
    v_cndmask_b32 v9, v5, v9, vcc
    v_mul_u32_u24 v14, 516096, v14
    v_bfe_u32 v15, v6, 2, 1
    v_mul_u32_u24 v15, 12288, v15
    v_add3_u32 v13, v4, v14, v15
    v_lshl_add_u32 v13, v8, 10, v13
    v_lshl_add_u32 v13, v9, 8, v13
    v_and_b32 v4, 3, v6
    v_lshl_add_u32 v13, v4, 6, v13
    v_and_b32 v4, 3, v2
    v_lshl_add_u32 v13, v4, 4, v13
    s_mov_b32 s34, 16386048
    v_cmp_le_u32 vcc, 32, v2
    v_mov_b32 v14, 0xc038aa3b
    v_mov_b32 v15, 0xbfb8aa3b
    v_cndmask_b32 v14, v14, v15, vcc
    v_mov_b32 v15, v14
    v_mul_f32 v160, 0x3ca57eb5, v14
    v_mov_b32 v161, v160
    v_mul_f32 v162, 0x3bba2e8c, v14
    v_mov_b32 v163, v162
    v_mul_f32 v164, 0x3ad1745d, v14
    v_mov_b32 v165, v164
    v_mul_f32 v166, 0x39eba2e9, v14
    v_mov_b32 v167, v166
    s_barrier
    s_waitcnt vmcnt(0)
    v_lshlrev_b32 v40, 16, v41
    v_and_b32 v41, s33, v41
    v_lshlrev_b32 v42, 16, v43
    v_and_b32 v43, s33, v43
    v_lshlrev_b32 v44, 16, v45
    v_and_b32 v45, s33, v45
    v_lshlrev_b32 v46, 16, v47
    v_and_b32 v47, s33, v47
    v_lshlrev_b32 v48, 16, v49
    v_and_b32 v49, s33, v49
    v_lshlrev_b32 v50, 16, v51
    v_and_b32 v51, s33, v51
    v_lshlrev_b32 v52, 16, v53
    v_and_b32 v53, s33, v53
    v_lshlrev_b32 v54, 16, v55
    v_and_b32 v55, s33, v55
    v_lshlrev_b32 v56, 16, v57
    v_and_b32 v57, s33, v57
    v_lshlrev_b32 v58, 16, v59
    v_and_b32 v59, s33, v59
    v_lshlrev_b32 v60, 16, v61
    v_and_b32 v61, s33, v61
    v_lshlrev_b32 v62, 16, v63
    v_and_b32 v63, s33, v63
    v_lshlrev_b32 v64, 16, v65
    v_and_b32 v65, s33, v65
    v_lshlrev_b32 v66, 16, v67
    v_and_b32 v67, s33, v67
    v_lshlrev_b32 v68, 16, v69
    v_and_b32 v69, s33, v69
    v_lshlrev_b32 v70, 16, v71
    v_and_b32 v71, s33, v71
    v_lshlrev_b32 v72, 16, v73
    v_and_b32 v73, s33, v73
    v_lshlrev_b32 v74, 16, v75
    v_and_b32 v75, s33, v75
    v_lshlrev_b32 v76, 16, v77
    v_and_b32 v77, s33, v77
    v_lshlrev_b32 v78, 16, v79
    v_and_b32 v79, s33, v79
    v_lshlrev_b32 v80, 16, v81
    v_and_b32 v81, s33, v81
    v_lshlrev_b32 v82, 16, v83
    v_and_b32 v83, s33, v83
    v_lshlrev_b32 v84, 16, v85
    v_and_b32 v85, s33, v85
    v_lshlrev_b32 v86, 16, v87
    v_and_b32 v87, s33, v87
    v_lshlrev_b32 v88, 16, v89
    v_and_b32 v89, s33, v89
    v_lshlrev_b32 v90, 16, v91
    v_and_b32 v91, s33, v91
    v_lshlrev_b32 v92, 16, v93
    v_and_b32 v93, s33, v93
    v_lshlrev_b32 v94, 16, v95
    v_and_b32 v95, s33, v95
    v_lshlrev_b32 v96, 16, v97
    v_and_b32 v97, s33, v97
    v_lshlrev_b32 v98, 16, v99
    v_and_b32 v99, s33, v99
    v_lshlrev_b32 v100, 16, v101
    v_and_b32 v101, s33, v101
    v_lshlrev_b32 v102, 16, v103
    v_and_b32 v103, s33, v103
    s_mov_b32 s53, 0
Lp_wloop:
    v_pk_mul_f32 v[104:105], v[160:161], v[40:41]
    v_pk_mul_f32 v[106:107], v[162:163], v[56:57]
    v_pk_fma_f32 v[104:105], v[164:165], v[72:73], v[104:105]
    v_pk_fma_f32 v[106:107], v[166:167], v[88:89], v[106:107]
    v_pk_add_f32 v[112:113], v[106:107], v[104:105]
    v_pk_add_f32 v[114:115], v[104:105], v[106:107] neg_lo:[0,1] neg_hi:[0,1]
    v_pk_mul_f32 v[108:109], v[160:161], v[42:43]
    v_pk_mul_f32 v[110:111], v[162:163], v[58:59]
    v_pk_fma_f32 v[108:109], v[164:165], v[74:75], v[108:109]
    v_pk_fma_f32 v[110:111], v[166:167], v[90:91], v[110:111]
    v_pk_add_f32 v[116:117], v[110:111], v[108:109]
    v_pk_add_f32 v[118:119], v[108:109], v[110:111] neg_lo:[0,1] neg_hi:[0,1]
    v_cvt_pk_bf16_f32 v120, v112, v116
    v_cvt_pk_bf16_f32 v124, v113, v117
    v_cvt_pk_bf16_f32 v128, v114, v118
    v_cvt_pk_bf16_f32 v132, v115, v119
    v_pk_mul_f32 v[104:105], v[160:161], v[44:45]
    v_pk_mul_f32 v[106:107], v[162:163], v[60:61]
    v_pk_fma_f32 v[104:105], v[164:165], v[76:77], v[104:105]
    v_pk_fma_f32 v[106:107], v[166:167], v[92:93], v[106:107]
    v_pk_add_f32 v[112:113], v[106:107], v[104:105]
    v_pk_add_f32 v[114:115], v[104:105], v[106:107] neg_lo:[0,1] neg_hi:[0,1]
    v_pk_mul_f32 v[108:109], v[160:161], v[46:47]
    v_pk_mul_f32 v[110:111], v[162:163], v[62:63]
    v_pk_fma_f32 v[108:109], v[164:165], v[78:79], v[108:109]
    v_pk_fma_f32 v[110:111], v[166:167], v[94:95], v[110:111]
    v_pk_add_f32 v[116:117], v[110:111], v[108:109]
    v_pk_add_f32 v[118:119], v[108:109], v[110:111] neg_lo:[0,1] neg_hi:[0,1]
    v_cvt_pk_bf16_f32 v121, v112, v116
    v_cvt_pk_bf16_f32 v125, v113, v117
    v_cvt_pk_bf16_f32 v129, v114, v118
    v_cvt_pk_bf16_f32 v133, v115, v119
    v_pk_mul_f32 v[104:105], v[160:161], v[48:49]
    v_pk_mul_f32 v[106:107], v[162:163], v[64:65]
    v_pk_fma_f32 v[104:105], v[164:165], v[80:81], v[104:105]
    v_pk_fma_f32 v[106:107], v[166:167], v[96:97], v[106:107]
    v_pk_add_f32 v[112:113], v[106:107], v[104:105]
    v_pk_add_f32 v[114:115], v[104:105], v[106:107] neg_lo:[0,1] neg_hi:[0,1]
    v_pk_mul_f32 v[108:109], v[160:161], v[50:51]
    v_pk_mul_f32 v[110:111], v[162:163], v[66:67]
    v_pk_fma_f32 v[108:109], v[164:165], v[82:83], v[108:109]
    v_pk_fma_f32 v[110:111], v[166:167], v[98:99], v[110:111]
    v_pk_add_f32 v[116:117], v[110:111], v[108:109]
    v_pk_add_f32 v[118:119], v[108:109], v[110:111] neg_lo:[0,1] neg_hi:[0,1]
    v_cvt_pk_bf16_f32 v122, v112, v116
    v_cvt_pk_bf16_f32 v126, v113, v117
    v_cvt_pk_bf16_f32 v130, v114, v118
    v_cvt_pk_bf16_f32 v134, v115, v119
    v_pk_mul_f32 v[104:105], v[160:161], v[52:53]
    v_pk_mul_f32 v[106:107], v[162:163], v[68:69]
    v_pk_fma_f32 v[104:105], v[164:165], v[84:85], v[104:105]
    v_pk_fma_f32 v[106:107], v[166:167], v[100:101], v[106:107]
    v_pk_add_f32 v[112:113], v[106:107], v[104:105]
    v_pk_add_f32 v[114:115], v[104:105], v[106:107] neg_lo:[0,1] neg_hi:[0,1]
    v_pk_mul_f32 v[108:109], v[160:161], v[54:55]
    v_pk_mul_f32 v[110:111], v[162:163], v[70:71]
    v_pk_fma_f32 v[108:109], v[164:165], v[86:87], v[108:109]
    v_pk_fma_f32 v[110:111], v[166:167], v[102:103], v[110:111]
    v_pk_add_f32 v[116:117], v[110:111], v[108:109]
    v_pk_add_f32 v[118:119], v[108:109], v[110:111] neg_lo:[0,1] neg_hi:[0,1]
    v_cvt_pk_bf16_f32 v123, v112, v116
    v_cvt_pk_bf16_f32 v127, v113, v117
    v_cvt_pk_bf16_f32 v131, v114, v118
    v_cvt_pk_bf16_f32 v135, v115, v119
    ds_write_b128 v10, v[120:123] offset:0
    ds_write_b128 v10, v[124:127] offset:16
    ds_write_b128 v10, v[128:131] offset:2048
    ds_write_b128 v10, v[132:135] offset:2064
    s_add_u32 s53, s53, 1
    s_waitcnt lgkmcnt(0)
    v_add_u32 v10, 4096, v10
    s_cmp_eq_u32 s53, 3
    s_cbranch_scc1 Lp_w3
    s_cmp_eq_u32 s53, 1
    s_cbranch_scc1 Lp_w1
    v_mul_f32 v160, 0x3e555eca, v14
    v_mov_b32 v161, v160
    v_mul_f32 v162, 0x3ebe086c, v14
    v_mov_b32 v163, v162
    v_mul_f32 v164, 0x3f293f80, v14
    v_mov_b32 v165, v164
    v_mul_f32 v166, 0x3f96bc8e, v14
    v_mov_b32 v167, v166
    s_waitcnt vmcnt(0)
    s_barrier
    s_branch Lp_wloop
Lp_w1:
    ds_read_b128 v[136:139], v11 offset:0
    ds_read_b128 v[140:143], v11 offset:1024
    ds_read_b128 v[144:147], v11 offset:2048
    ds_read_b128 v[148:151], v11 offset:3072
    s_waitcnt lgkmcnt(3)
    buffer_store_dwordx4 v[136:139], v12, s[20:23], s34 offen sc1
    s_waitcnt lgkmcnt(2)
    buffer_store_dwordx4 v[140:143], v13, s[20:23], s34 offen sc1
    s_add_u32 s34, s34, 73728
    s_waitcnt lgkmcnt(1)
    buffer_store_dwordx4 v[144:147], v12, s[20:23], s34 offen sc1
    s_waitcnt lgkmcnt(0)
    buffer_store_dwordx4 v[148:151], v13, s[20:23], s34 offen sc1
    s_add_u32 s34, s34, 73728
    v_mul_f32 v160, 0xbe6a0ea1, v14
    v_mov_b32 v161, v160
    v_mul_f32 v162, 0xbe457c58, v14
    v_mov_b32 v163, v162
    v_mul_f32 v164, 0xbe26a0ea, v14
    v_mov_b32 v165, v164
    v_mul_f32 v166, 0xbe0c97c5, v14
    v_mov_b32 v167, v166
    s_branch Lp_wloop
Lp_w3:
    v_pk_mul_f32 v[88:89], v[88:89], v[14:15]
    v_pk_mul_f32 v[90:91], v[90:91], v[14:15]
    v_pk_mul_f32 v[92:93], v[92:93], v[14:15]
    v_pk_mul_f32 v[94:95], v[94:95], v[14:15]
    v_pk_mul_f32 v[96:97], v[96:97], v[14:15]
    v_pk_mul_f32 v[98:99], v[98:99], v[14:15]
    v_pk_mul_f32 v[100:101], v[100:101], v[14:15]
    v_pk_mul_f32 v[102:103], v[102:103], v[14:15]
    v_cvt_pk_bf16_f32 v120, v88, v90
    v_cvt_pk_bf16_f32 v121, v92, v94
    v_cvt_pk_bf16_f32 v122, v96, v98
    v_cvt_pk_bf16_f32 v123, v100, v102
    ds_write_b128 v10, v[120:123] offset:0
    v_cvt_pk_bf16_f32 v124, v89, v91
    v_cvt_pk_bf16_f32 v125, v93, v95
    v_cvt_pk_bf16_f32 v126, v97, v99
    v_cvt_pk_bf16_f32 v127, v101, v103
    ds_write_b128 v10, v[124:127] offset:16
    s_waitcnt lgkmcnt(0)
    ds_read_b128 v[184:187], v11 offset:4096
    ds_read_b128 v[188:191], v11 offset:5120
    ds_read_b128 v[200:203], v11 offset:6144
    ds_read_b128 v[204:207], v11 offset:7168
    ds_read_b128 v[216:219], v11 offset:8192
    ds_read_b128 v[220:223], v11 offset:9216
    ds_read_b128 v[232:235], v11 offset:10240
    ds_read_b128 v[236:239], v11 offset:11264
    ds_read_b128 v[248:251], v11 offset:12288
    ds_read_b128 v[252:255], v11 offset:13312
    v_add_u32 v32, s34, v12
    v_add_u32 v33, s34, v13
    s_mov_b32 s96, 73728
    s_mov_b32 s97, 73728
    s_waitcnt lgkmcnt(0)
Lp_wx:
    s_cmp_ge_u32 s2, 250
    s_cbranch_scc1 L_pdone
    s_mov_b32 s36, 0x3e808020
    s_mov_b32 s37, 0x3e808020
    s_mov_b32 s38, 0xc0502000
    s_mov_b32 s39, 0xc0502000
    s_mov_b32 s40, 0x3f580000
    s_mov_b32 s41, 0x3f580000
    s_mov_b32 s42, 0x3d66a900
    s_mov_b32 s43, 0x3d66a900
    s_mov_b32 s44, 0xbf4a8000
    s_mov_b32 s45, 0xbf4a8000
    s_mov_b32 s46, 0x3fe40000
    s_mov_b32 s47, 0x3fe40000
    s_mov_b32 s48, 0xbe36f66e
    s_mov_b32 s49, 0xbe36f66e
    s_mov_b32 s52, 0x40243acc
    s_mov_b32 s53, 0x40243acc
    s_mov_b32 s54, 0xc07db000
    s_mov_b32 s55, 0xc07db000
    s_add_u32 s34, s50, 1170432
    s_mov_b32 s30, 8
    s_cmp_eq_u32 s26, 4
    s_cbranch_scc1 Lp_x3
    s_mov_b32 s30, 4
    s_branch Lp_x23
Lp_wo:
    s_waitcnt lgkmcnt(0)
    s_mov_b32 s20, s58
    s_and_b32 s21, s59, 0xffff
    s_mov_b32 s22, 30497792
    s_mov_b32 s23, 0x00020000
    s_mov_b32 s16, s56
    s_and_b32 s17, s57, 0xffff
    s_mov_b32 s18, 256
    s_mov_b32 s19, 0x00020000
    s_mov_b32 s33, 0xffff0000
    v_mov_b32 v37, 0
    v_mov_b32 v32, 2130706432
    v_mov_b32 v33, 2130706432
    v_mov_b32 v34, 2130706432
    v_mov_b32 v35, 2130706432
    s_mov_b32 s96, 585216
    s_mov_b32 s97, 585216
    s_mov_b32 s98, 585216
    s_mov_b32 s99, 585216
    s_mov_b32 s31, 0
    s_mov_b32 s92, 0
    s_mov_b32 s93, 0
    s_cmp_ge_u32 s2, 125
    s_cselect_b32 s50, 8001024, 0
    s_mul_i32 s51, s2, 1536
    s_add_u32 s50, s50, 768
    s_add_u32 s50, s50, s51
    s_add_u32 s51, s50, 585216
    s_mov_b32 s35, 114752
    s_sub_u32 s3, s2, 72
    s_cmp_ge_u32 s3, 45
    s_cbranch_scc1 Lp_wo2
    s_mov_b32 s12, s8
    s_and_b32 s13, s9, 0xffff
    s_mov_b32 s14, 41472
    s_mov_b32 s15, 0x00020000
    s_mul_i32 s28, s3, 13108
    s_lshr_b32 s28, s28, 16
    s_mul_i32 s29, s28, 5
    s_sub_u32 s29, s3, s29
    v_and_b32 v7, 15, v2
    v_lshrrev_b32 v8, 4, v2
    s_cmp_eq_u32 s28, 8
    s_cselect_b32 s30, 1, 4
    s_cselect_b32 s34, 256, 0
    s_cselect_b32 s28, 0, s28
    s_lshl_b32 s28, s28, 1
    s_add_u32 s34, s34, s28
    s_mul_i32 s29, s29, 9216
    s_add_u32 s34, s34, s29
    v_lshlrev_b32 v9, s30, v7
    v_mul_u32_u24 v14, 576, v8
    v_add3_u32 v14, v14, v9, s34
    buffer_load_ushort v40, v14, s[12:15], 0 offen
    buffer_load_ushort v41, v14, s[12:15], 0 offen offset:288
    v_add_u32 v14, 2304, v14
    buffer_load_ushort v42, v14, s[12:15], 0 offen
    buffer_load_ushort v43, v14, s[12:15], 0 offen offset:288
    v_add_u32 v14, 2304, v14
    buffer_load_ushort v44, v14, s[12:15], 0 offen
    buffer_load_ushort v45, v14, s[12:15], 0 offen offset:288
    v_add_u32 v14, 2304, v14
    buffer_load_ushort v46, v14, s[12:15], 0 offen
    buffer_load_ushort v47, v14, s[12:15], 0 offen offset:288
    s_lshl_b32 s3, s3, 10
    s_add_u32 s3, s3, 30451712
    v_lshlrev_b32 v1, 4, v2
    s_barrier
    s_waitcnt vmcnt(0)
    v_lshl_or_b32 v48, v41, 16, v40
    v_lshl_or_b32 v49, v43, 16, v42
    v_lshl_or_b32 v50, v45, 16, v44
    v_lshl_or_b32 v51, v47, 16, v46
    buffer_store_dwordx4 v[48:51], v1, s[20:23], s3 offen sc1
    s_waitcnt vmcnt(0)
    s_barrier
    s_branch Lp_wx
Lp_wo2:
    s_barrier
    s_barrier
    s_branch Lp_wx
L_pdone:
    v_lshlrev_b32 v101, 4, v2
    v_min_u32 v36, 62, v2
    v_lshlrev_b32 v36, 5, v36
    s_and_b32 s30, s2, 0
    s_mul_i32 s30, s30, 4352
    v_add_u32 v36, s30, v36
    v_mul_u32_u24 v12, 4352, v2
    s_and_b32 s25, s2, 7
    s_lshr_b32 s24, s2, 3
    s_mul_i32 s27, s25, 31
    s_min_u32 s28, s25, 4
    s_add_u32 s27, s27, s28
    s_add_u32 s27, s27, s24
    s_mul_i32 s28, s27, 7282
    s_lshr_b32 s28, s28, 16
    s_mul_i32 s29, s28, 9
    s_sub_u32 s29, s27, s29
    s_and_b32 s24, s26, 3
    s_lshr_b32 s32, s24, 1
    s_and_b32 s33, s24, 1
    s_mul_i32 s34, s24, 7168
    s_mul_i32 s35, s24, 6144
    s_lshl_b32 s62, s28, 1
    s_add_u32 s62, s62, s32
    s_mul_i32 s62, s62, 165888
    s_lshl_b32 s63, s29, 1
    s_add_u32 s63, s63, s33
    s_lshl_b32 s63, s63, 8
    s_add_u32 s62, s62, s63
    s_add_u32 s62, s62, 21030912
    s_lshr_b32 s38, s28, 1
    s_and_b32 s30, s28, 1
    s_cmp_ge_u32 s38, 7
    s_cselect_b32 s36, 7, 0
    s_cselect_b32 s37, 2, 0
    s_sub_u32 s38, s38, s36
    s_add_u32 s30, s30, s37
    s_mul_i32 s36, s30, 4096512
    s_mul_i32 s37, s38, 27648
    s_add_u32 s36, s36, s37
    s_add_u32 s36, s36, s34
    s_mul_i32 s37, s29, 516096
    s_add_u32 s37, s37, s35
    s_add_u32 s37, s37, 16386048
    s_cmp_eq_u32 s38, 6
    s_cselect_b32 s60, 16, 64
    s_cselect_b32 s61, 0, 64
    v_mov_b32 v8, 2130706432
    v_cmp_gt_u32 vcc, s60, v2
    v_cmp_gt_u32 s[88:89], s61, v2
    s_nop 0
    v_cndmask_b32 v6, v8, v101, vcc
    v_cndmask_b32 v7, v8, v101, s[88:89]
    s_cmp_ge_u32 s26, 4
    s_cbranch_scc1 L_helper
    s_cmp_lg_u32 s26, 0
    s_cbranch_scc1 L_c13
    s_cmp_lg_u32 s2, 0
    s_cbranch_scc1 L_gow
    s_mov_b32 s31, 0
L_pollA:
    s_mov_b32 s30, 30320640
    buffer_load_dwordx4 v[24:27], v36, s[20:23], s30 offen sc1
    buffer_load_dwordx4 v[28:31], v36, s[20:23], s30 offen offset:16 sc1
    s_add_u32 s31, s31, 1
    s_cmp_gt_u32 s31, 400000
    s_cbranch_scc1 L_pdoneA
    s_waitcnt vmcnt(0)
    v_cmp_ne_u64 vcc, s[92:93], v[24:25]
    v_cmp_ne_u64 s[88:89], s[92:93], v[26:27]
    s_or_b64 vcc, vcc, s[88:89]
    v_cmp_ne_u64 s[88:89], s[92:93], v[28:29]
    s_or_b64 vcc, vcc, s[88:89]
    v_cmp_ne_u64 s[88:89], s[92:93], v[30:31]
    s_or_b64 vcc, vcc, s[88:89]
    s_cbranch_scc0 L_pdoneA
    s_mov_b64 exec, vcc
    s_sleep 1
    s_branch L_pollA
L_pdoneA:
    s_mov_b64 exec, -1
    s_mov_b32 s30, 30350592
    v_mul_u32_u24 v9, 4352, v2
    s_mov_b64 exec, 0xff
    buffer_store_dwordx2 v[38:39], v9, s[20:23], s30 offen sc1
    s_mov_b64 exec, -1
    s_branch L_god
L_gow:
    s_mul_i32 s30, s25, 4352
    s_add_u32 s30, s30, 30350592
    s_mov_b32 s31, 0
    s_mov_b64 exec, 1
L_gol:
    buffer_load_dwordx2 v[24:25], v37, s[20:23], s30 offen sc1
    s_add_u32 s31, s31, 1
    s_cmp_gt_u32 s31, 800000
    s_cbranch_scc1 L_gox
    s_waitcnt vmcnt(0)
    v_cmp_ne_u64 vcc, s[92:93], v[24:25]
    s_cbranch_vccz L_gox
    s_sleep 2
    s_branch L_gol
L_gox:
    s_mov_b64 exec, -1
L_god:
    s_mov_b32 m0, 0
    s_add_u32 s30, s36, 0
    buffer_load_dwordx4 v101, s[20:23], s30 offen offset:0 sc1 lds
    buffer_load_dwordx4 v101, s[20:23], s30 offen offset:1024 sc1 lds
    buffer_load_dwordx4 v101, s[20:23], s30 offen offset:2048 sc1 lds
    buffer_load_dwordx4 v101, s[20:23], s30 offen offset:3072 sc1 lds
    s_mov_b32 m0, 4096
    s_add_u32 s30, s36, 4096
    buffer_load_dwordx4 v101, s[20:23], s30 offen offset:0 sc1 lds
    buffer_load_dwordx4 v101, s[20:23], s30 offen offset:1024 sc1 lds
    buffer_load_dwordx4 v101, s[20:23], s30 offen offset:2048 sc1 lds
    buffer_load_dwordx4 v101, s[20:23], s30 offen offset:3072 sc1 lds
    s_mov_b32 m0, 8192
    s_add_u32 s30, s36, 8192
    buffer_load_dwordx4 v101, s[20:23], s30 offen offset:0 sc1 lds
    buffer_load_dwordx4 v101, s[20:23], s30 offen offset:1024 sc1 lds
    buffer_load_dwordx4 v101, s[20:23], s30 offen offset:2048 sc1 lds
    buffer_load_dwordx4 v101, s[20:23], s30 offen offset:3072 sc1 lds
    s_mov_b32 m0, 12288
    s_add_u32 s30, s36, 12288
    buffer_load_dwordx4 v101, s[20:23], s30 offen offset:0 sc1 lds
    buffer_load_dwordx4 v101, s[20:23], s30 offen offset:1024 sc1 lds
    buffer_load_dwordx4 v101, s[20:23], s30 offen offset:2048 sc1 lds
    buffer_load_dwordx4 v101, s[20:23], s30 offen offset:3072 sc1 lds
    s_mov_b32 m0, 16384
    s_add_u32 s30, s36, 16384
    buffer_load_dwordx4 v101, s[20:23], s30 offen offset:0 sc1 lds
    buffer_load_dwordx4 v101, s[20:23], s30 offen offset:1024 sc1 lds
    buffer_load_dwordx4 v101, s[20:23], s30 offen offset:2048 sc1 lds
    buffer_load_dwordx4 v101, s[20:23], s30 offen offset:3072 sc1 lds
    s_mov_b32 m0, 20480
    s_add_u32 s30, s36, 20480
    buffer_load_dwordx4 v101, s[20:23], s30 offen offset:0 sc1 lds
    buffer_load_dwordx4 v101, s[20:23], s30 offen offset:1024 sc1 lds
    buffer_load_dwordx4 v101, s[20:23], s30 offen offset:2048 sc1 lds
    buffer_load_dwordx4 v101, s[20:23], s30 offen offset:3072 sc1 lds
    s_mov_b32 m0, 24576
    s_add_u32 s30, s36, 24576
    buffer_load_dwordx4 v101, s[20:23], s30 offen offset:0 sc1 lds
    buffer_load_dwordx4 v101, s[20:23], s30 offen offset:1024 sc1 lds
    buffer_load_dwordx4 v6, s[20:23], s30 offen offset:2048 sc1 lds
    buffer_load_dwordx4 v7, s[20:23], s30 offen offset:3072 sc1 lds
    s_mov_b32 m0, 28672
    s_add_u32 s30, s37, 0
    buffer_load_dwordx4 v101, s[20:23], s30 offen offset:0 sc1 lds
    buffer_load_dwordx4 v101, s[20:23], s30 offen offset:1024 sc1 lds
    buffer_load_dwordx4 v101, s[20:23], s30 offen offset:2048 sc1 lds
    buffer_load_dwordx4 v101, s[20:23], s30 offen offset:3072 sc1 lds
    s_mov_b32 m0, 32768
    s_add_u32 s30, s37, 4096
    buffer_load_dwordx4 v101, s[20:23], s30 offen offset:0 sc1 lds
    buffer_load_dwordx4 v101, s[20:23], s30 offen offset:1024 sc1 lds
    buffer_load_dwordx4 v101, s[20:23], s30 offen offset:2048 sc1 lds
    buffer_load_dwordx4 v101, s[20:23], s30 offen offset:3072 sc1 lds
    s_mov_b32 m0, 36864
    s_add_u32 s30, s37, 8192
    buffer_load_dwordx4 v101, s[20:23], s30 offen offset:0 sc1 lds
    buffer_load_dwordx4 v101, s[20:23], s30 offen offset:1024 sc1 lds
    buffer_load_dwordx4 v101, s[20:23], s30 offen offset:2048 sc1 lds
    buffer_load_dwordx4 v101, s[20:23], s30 offen offset:3072 sc1 lds
    s_mov_b32 m0, 40960
    s_add_u32 s30, s37, 12288
    buffer_load_dwordx4 v101, s[20:23], s30 offen offset:0 sc1 lds
    buffer_load_dwordx4 v101, s[20:23], s30 offen offset:1024 sc1 lds
    buffer_load_dwordx4 v101, s[20:23], s30 offen offset:2048 sc1 lds
    buffer_load_dwordx4 v101, s[20:23], s30 offen offset:3072 sc1 lds
    s_mov_b32 m0, 45056
    s_add_u32 s30, s37, 16384
    buffer_load_dwordx4 v101, s[20:23], s30 offen offset:0 sc1 lds
    buffer_load_dwordx4 v101, s[20:23], s30 offen offset:1024 sc1 lds
    buffer_load_dwordx4 v101, s[20:23], s30 offen offset:2048 sc1 lds
    buffer_load_dwordx4 v101, s[20:23], s30 offen offset:3072 sc1 lds
    s_mov_b32 m0, 49152
    s_add_u32 s30, s37, 20480
    buffer_load_dwordx4 v101, s[20:23], s30 offen offset:0 sc1 lds
    buffer_load_dwordx4 v101, s[20:23], s30 offen offset:1024 sc1 lds
    buffer_load_dwordx4 v101, s[20:23], s30 offen offset:2048 sc1 lds
    buffer_load_dwordx4 v101, s[20:23], s30 offen offset:3072 sc1 lds
L_c13:
    s_barrier
    s_setprio 1
    v_and_b32 v124, 15, v2
    v_lshrrev_b32 v125, 4, v2
    v_mul_u32_u24 v126, 864, v124
    s_mul_i32 s38, s32, 13824
    v_add_u32 v126, s38, v126
    v_lshl_add_u32 v2, v125, 4, v126
    v_lshrrev_b32 v127, 1, v125
    v_mul_u32_u24 v127, 96, v127
    v_sub_u32 v127, v126, v127
    v_and_b32 v128, 1, v125
    v_lshl_add_u32 v127, v128, 4, v127
    v_add_u32 v5, 160, v127
    s_mul_i32 s38, s33, 12288
    s_add_u32 s38, s38, 28672
    v_add_u32 v8, s38, v101
    v_add_u32 v3, 53248, v2
    v_add_u32 v6, 53248, v5
    v_add_u32 v9, 53248, v8
    v_add_u32 v4, 106496, v2
    v_add_u32 v7, 106496, v5
    v_add_u32 v10, 106496, v8
    s_add_u32 s38, s34, 106496
    v_add_u32 v1, s38, v101
    s_add_u32 s38, s35, 135168
    v_add_u32 v11, s38, v101
    v_mov_b32 v48, 0
    v_mov_b32 v49, 0
    v_mov_b32 v50, 0
    v_mov_b32 v51, 0
    v_mov_b32 v52, 0
    v_mov_b32 v53, 0
    v_mov_b32 v54, 0
    v_mov_b32 v55, 0
    v_mov_b32 v56, 0
    v_mov_b32 v57, 0
    v_mov_b32 v58, 0
    v_mov_b32 v59, 0
    v_mov_b32 v60, 0
    v_mov_b32 v61, 0
    v_mov_b32 v62, 0
    v_mov_b32 v63, 0
    v_mov_b32 v64, 0
    v_mov_b32 v65, 0
    v_mov_b32 v66, 0
    v_mov_b32 v67, 0
    v_mov_b32 v68, 0
    v_mov_b32 v69, 0
    v_mov_b32 v70, 0
    v_mov_b32 v71, 0
    v_mov_b32 v72, 0
    v_mov_b32 v73, 0
    v_mov_b32 v74, 0
    v_mov_b32 v75, 0
    v_mov_b32 v76, 0
    v_mov_b32 v77, 0
    v_mov_b32 v78, 0
    v_mov_b32 v79, 0
    v_mov_b32 v80, 0
    v_mov_b32 v81, 0
    v_mov_b32 v82, 0
    v_mov_b32 v83, 0
    s_waitcnt vmcnt(0)
    s_barrier
    ds_read_b128 v[84:87], v2 offset:96
    ds_read_b128 v[88:91], v8 offset:7168
    ds_read_b128 v[92:95], v2 offset:192
    ds_read_b128 v[96:99], v8 offset:6144
    ds_read_b128 v[100:103], v2 offset:288
    ds_read_b128 v[104:107], v8 offset:5120
    ds_read_b128 v[108:111], v2 offset:384
    ds_read_b128 v[112:115], v8 offset:4096
    ds_read_b128 v[116:119], v2 offset:480
    ds_read_b128 v[120:123], v8 offset:3072
    ds_read_b128 v[124:127], v2 offset:576
    ds_read_b128 v[128:131], v8 offset:2048
    ds_read_b128 v[132:135], v2 offset:672
    ds_read_b128 v[136:139], v8 offset:1024
    ds_read_b128 v[140:143], v2 offset:768
    ds_read_b128 v[144:147], v8 offset:0
    ds_read_b128 v[148:151], v2 offset:864
    s_mov_b32 s39, 7
    s_waitcnt lgkmcnt(0)
.p2align 6
L_loop:
    s_waitcnt lgkmcnt(7)
    v_mfma_f32_16x16x32_bf16 v[12:15], v[88:91], v[84:87], v[48:51]
    v_mfma_f32_16x16x32_bf16 v[12:15], v[96:99], v[92:95], v[12:15]
    ds_read_b128 v[152:155], v2 offset:960
    v_mfma_f32_16x16x32_bf16 v[12:15], v[104:107], v[100:103], v[12:15]
    v_mfma_f32_16x16x32_bf16 v[12:15], v[112:115], v[108:111], v[12:15]
    v_mfma_f32_16x16x32_bf16 v[12:15], v[120:123], v[116:119], v[12:15]
    ds_read_b128 v[156:159], v2 offset:1056
    v_mfma_f32_16x16x32_bf16 v[12:15], v[128:131], v[124:127], v[12:15]
    ds_write_b128 v1, v[68:71] offset:5120
    s_waitcnt lgkmcnt(5)
    v_mfma_f32_16x16x32_bf16 v[12:15], v[136:139], v[132:135], v[12:15]
    v_mfma_f32_16x16x32_bf16 v[12:15], v[144:147], v[140:143], v[12:15]
    ds_read_b128 v[160:163], v2 offset:1152
    v_mfma_f32_16x16x32_bf16 v[16:19], v[88:91], v[92:95], v[52:55]
    v_mfma_f32_16x16x32_bf16 v[16:19], v[96:99], v[100:103], v[16:19]
    v_mfma_f32_16x16x32_bf16 v[16:19], v[104:107], v[108:111], v[16:19]
    ds_read_b128 v[164:167], v2 offset:1248
    v_mfma_f32_16x16x32_bf16 v[16:19], v[112:115], v[116:119], v[16:19]
    ds_write_b128 v1, v[72:75] offset:6144
    v_mfma_f32_16x16x32_bf16 v[16:19], v[120:123], v[124:127], v[16:19]
    v_mfma_f32_16x16x32_bf16 v[16:19], v[128:131], v[132:135], v[16:19]
    ds_read_b128 v[168:171], v2 offset:1344
    v_mfma_f32_16x16x32_bf16 v[16:19], v[136:139], v[140:143], v[16:19]
    s_waitcnt lgkmcnt(4)
    v_mfma_f32_16x16x32_bf16 v[16:19], v[144:147], v[148:151], v[16:19]
    v_mfma_f32_16x16x32_bf16 v[20:23], v[88:91], v[100:103], v[56:59]
    ds_read_b128 v[172:175], v2 offset:1440
    v_mfma_f32_16x16x32_bf16 v[20:23], v[96:99], v[108:111], v[20:23]
    ds_write_b128 v11, v[76:79] offset:0
    v_mfma_f32_16x16x32_bf16 v[20:23], v[104:107], v[116:119], v[20:23]
    v_mfma_f32_16x16x32_bf16 v[20:23], v[112:115], v[124:127], v[20:23]
    ds_read_b128 v[176:179], v2 offset:1536
    v_mfma_f32_16x16x32_bf16 v[20:23], v[120:123], v[132:135], v[20:23]
    v_mfma_f32_16x16x32_bf16 v[20:23], v[128:131], v[140:143], v[20:23]
    v_mfma_f32_16x16x32_bf16 v[20:23], v[136:139], v[148:151], v[20:23]
    ds_read_b128 v[180:183], v5 offset:96
    v_mfma_f32_16x16x32_bf16 v[20:23], v[144:147], v[152:155], v[20:23]
    ds_write_b128 v11, v[80:83] offset:1024
    v_mfma_f32_16x16x32_bf16 v[24:27], v[88:91], v[108:111], v[60:63]
    v_mfma_f32_16x16x32_bf16 v[24:27], v[96:99], v[116:119], v[24:27]
    ds_read_b128 v[184:187], v8 offset:11264
    v_mfma_f32_16x16x32_bf16 v[24:27], v[104:107], v[124:127], v[24:27]
    v_mfma_f32_16x16x32_bf16 v[24:27], v[112:115], v[132:135], v[24:27]
    s_waitcnt lgkmcnt(1)
    s_barrier
    v_mfma_f32_16x16x32_bf16 v[24:27], v[120:123], v[140:143], v[24:27]
    ds_read_b128 v[188:191], v5 offset:288
    v_mfma_f32_16x16x32_bf16 v[24:27], v[128:131], v[148:151], v[24:27]
    v_mfma_f32_16x16x32_bf16 v[24:27], v[136:139], v[152:155], v[24:27]
    v_mfma_f32_16x16x32_bf16 v[24:27], v[144:147], v[156:159], v[24:27]
    ds_read_b128 v[192:195], v8 offset:10240
    v_mfma_f32_16x16x32_bf16 v[28:31], v[88:91], v[116:119], v[64:67]
    v_mfma_f32_16x16x32_bf16 v[28:31], v[96:99], v[124:127], v[28:31]
    v_mfma_f32_16x16x32_bf16 v[28:31], v[104:107], v[132:135], v[28:31]
    ds_read_b128 v[196:199], v5 offset:480
    v_mfma_f32_16x16x32_bf16 v[28:31], v[112:115], v[140:143], v[28:31]
    v_mfma_f32_16x16x32_bf16 v[28:31], v[120:123], v[148:151], v[28:31]
    v_mfma_f32_16x16x32_bf16 v[28:31], v[128:131], v[152:155], v[28:31]
    ds_read_b128 v[200:203], v8 offset:9216
    v_mfma_f32_16x16x32_bf16 v[28:31], v[136:139], v[156:159], v[28:31]
    v_mfma_f32_16x16x32_bf16 v[28:31], v[144:147], v[160:163], v[28:31]
    v_mfma_f32_16x16x32_bf16 v[32:35], v[88:91], v[124:127], v[68:71]
    ds_read_b128 v[204:207], v5 offset:672
    v_mfma_f32_16x16x32_bf16 v[32:35], v[96:99], v[132:135], v[32:35]
    v_mfma_f32_16x16x32_bf16 v[32:35], v[104:107], v[140:143], v[32:35]
    v_mfma_f32_16x16x32_bf16 v[32:35], v[112:115], v[148:151], v[32:35]
    ds_read_b128 v[208:211], v8 offset:8192
    v_mfma_f32_16x16x32_bf16 v[32:35], v[120:123], v[152:155], v[32:35]
    v_mfma_f32_16x16x32_bf16 v[32:35], v[128:131], v[156:159], v[32:35]
    v_mfma_f32_16x16x32_bf16 v[32:35], v[136:139], v[160:163], v[32:35]
    ds_read_b128 v[212:215], v5 offset:192
    v_mfma_f32_16x16x32_bf16 v[32:35], v[144:147], v[164:167], v[32:35]
    v_mfma_f32_16x16x32_bf16 v[36:39], v[88:91], v[132:135], v[72:75]
    v_mfma_f32_16x16x32_bf16 v[36:39], v[96:99], v[140:143], v[36:39]
    ds_read_b128 v[216:219], v5 offset:384
    v_mfma_f32_16x16x32_bf16 v[36:39], v[104:107], v[148:151], v[36:39]
    v_mfma_f32_16x16x32_bf16 v[36:39], v[112:115], v[152:155], v[36:39]
    v_mfma_f32_16x16x32_bf16 v[36:39], v[120:123], v[156:159], v[36:39]
    ds_read_b128 v[220:223], v5 offset:576
    v_mfma_f32_16x16x32_bf16 v[36:39], v[128:131], v[160:163], v[36:39]
    v_mfma_f32_16x16x32_bf16 v[36:39], v[136:139], v[164:167], v[36:39]
    v_mfma_f32_16x16x32_bf16 v[36:39], v[144:147], v[168:171], v[36:39]
    ds_read_b128 v[224:227], v5 offset:768
    v_mfma_f32_16x16x32_bf16 v[40:43], v[88:91], v[140:143], v[76:79]
    v_mfma_f32_16x16x32_bf16 v[40:43], v[96:99], v[148:151], v[40:43]
    v_mfma_f32_16x16x32_bf16 v[40:43], v[104:107], v[152:155], v[40:43]
    ds_read_b128 v[228:231], v5 offset:864
    v_mfma_f32_16x16x32_bf16 v[40:43], v[112:115], v[156:159], v[40:43]
    v_mfma_f32_16x16x32_bf16 v[40:43], v[120:123], v[160:163], v[40:43]
    v_mfma_f32_16x16x32_bf16 v[40:43], v[128:131], v[164:167], v[40:43]
    ds_read_b128 v[232:235], v5 offset:960
    v_mfma_f32_16x16x32_bf16 v[40:43], v[136:139], v[168:171], v[40:43]
    v_mfma_f32_16x16x32_bf16 v[40:43], v[144:147], v[172:175], v[40:43]
    v_mfma_f32_16x16x32_bf16 v[44:47], v[88:91], v[148:151], v[80:83]
    ds_read_b128 v[236:239], v5 offset:1056
    v_mfma_f32_16x16x32_bf16 v[44:47], v[96:99], v[152:155], v[44:47]
    v_mfma_f32_16x16x32_bf16 v[44:47], v[104:107], v[156:159], v[44:47]
    v_mfma_f32_16x16x32_bf16 v[44:47], v[112:115], v[160:163], v[44:47]
    ds_read_b128 v[240:243], v5 offset:1152
    v_mfma_f32_16x16x32_bf16 v[44:47], v[120:123], v[164:167], v[44:47]
    v_mfma_f32_16x16x32_bf16 v[44:47], v[128:131], v[168:171], v[44:47]
    v_mfma_f32_16x16x32_bf16 v[44:47], v[136:139], v[172:175], v[44:47]
    ds_read_b128 v[244:247], v5 offset:1248
    v_mfma_f32_16x16x32_bf16 v[44:47], v[144:147], v[176:179], v[44:47]
    s_waitcnt lgkmcnt(3)
    v_mfma_f32_16x16x32_bf16 v[12:15], v[184:187], v[180:183], v[12:15]
    v_mfma_f32_16x16x32_bf16 v[12:15], v[192:195], v[188:191], v[12:15]
    ds_read_b128 v[248:251], v5 offset:1344
    v_mfma_f32_16x16x32_bf16 v[12:15], v[200:203], v[196:199], v[12:15]
    v_mfma_f32_16x16x32_bf16 v[12:15], v[208:211], v[204:207], v[12:15]
    v_mfma_f32_16x16x32_bf16 v[16:19], v[184:187], v[212:215], v[16:19]
    ds_read_b128 v[252:255], v5 offset:1440
    v_mfma_f32_16x16x32_bf16 v[16:19], v[192:195], v[216:219], v[16:19]
    v_mfma_f32_16x16x32_bf16 v[16:19], v[200:203], v[220:223], v[16:19]
    v_mfma_f32_16x16x32_bf16 v[16:19], v[208:211], v[224:227], v[16:19]
    v_mfma_f32_16x16x32_bf16 v[20:23], v[184:187], v[188:191], v[20:23]
    v_mfma_f32_16x16x32_bf16 v[20:23], v[192:195], v[196:199], v[20:23]
    s_waitcnt lgkmcnt(0)
    s_barrier
    v_mfma_f32_16x16x32_bf16 v[20:23], v[200:203], v[204:207], v[20:23]
    ds_read_b128 v[84:87], v3 offset:96
    v_mfma_f32_16x16x32_bf16 v[20:23], v[208:211], v[228:231], v[20:23]
    ds_read_b128 v[88:91], v9 offset:7168
    v_mfma_f32_16x16x32_bf16 v[24:27], v[184:187], v[216:219], v[24:27]
    v_mfma_f32_16x16x32_bf16 v[24:27], v[192:195], v[220:223], v[24:27]
    ds_read_b128 v[92:95], v3 offset:192
    v_mfma_f32_16x16x32_bf16 v[24:27], v[200:203], v[224:227], v[24:27]
    ds_read_b128 v[96:99], v9 offset:6144
    v_mfma_f32_16x16x32_bf16 v[24:27], v[208:211], v[232:235], v[24:27]
    v_mfma_f32_16x16x32_bf16 v[28:31], v[184:187], v[196:199], v[28:31]
    ds_read_b128 v[100:103], v3 offset:288
    v_mfma_f32_16x16x32_bf16 v[28:31], v[192:195], v[204:207], v[28:31]
    ds_read_b128 v[104:107], v9 offset:5120
    v_mfma_f32_16x16x32_bf16 v[28:31], v[200:203], v[228:231], v[28:31]
    v_mfma_f32_16x16x32_bf16 v[28:31], v[208:211], v[236:239], v[28:31]
    ds_read_b128 v[108:111], v3 offset:384
    v_mfma_f32_16x16x32_bf16 v[32:35], v[184:187], v[220:223], v[32:35]
    ds_read_b128 v[112:115], v9 offset:4096
    v_mfma_f32_16x16x32_bf16 v[32:35], v[192:195], v[224:227], v[32:35]
    v_mfma_f32_16x16x32_bf16 v[32:35], v[200:203], v[232:235], v[32:35]
    ds_read_b128 v[116:119], v3 offset:480
    v_mfma_f32_16x16x32_bf16 v[32:35], v[208:211], v[240:243], v[32:35]
    ds_read_b128 v[120:123], v9 offset:3072
    v_mfma_f32_16x16x32_bf16 v[36:39], v[184:187], v[204:207], v[36:39]
    v_mfma_f32_16x16x32_bf16 v[36:39], v[192:195], v[228:231], v[36:39]
    ds_read_b128 v[124:127], v3 offset:576
    v_mfma_f32_16x16x32_bf16 v[36:39], v[200:203], v[236:239], v[36:39]
    ds_read_b128 v[128:131], v9 offset:2048
    v_mfma_f32_16x16x32_bf16 v[36:39], v[208:211], v[244:247], v[36:39]
    v_mfma_f32_16x16x32_bf16 v[40:43], v[184:187], v[224:227], v[40:43]
    ds_read_b128 v[132:135], v3 offset:672
    v_mfma_f32_16x16x32_bf16 v[40:43], v[192:195], v[232:235], v[40:43]
    ds_read_b128 v[136:139], v9 offset:1024
    v_mfma_f32_16x16x32_bf16 v[40:43], v[200:203], v[240:243], v[40:43]
    v_mfma_f32_16x16x32_bf16 v[40:43], v[208:211], v[248:251], v[40:43]
    ds_read_b128 v[140:143], v3 offset:768
    v_mfma_f32_16x16x32_bf16 v[44:47], v[184:187], v[228:231], v[44:47]
    ds_read_b128 v[144:147], v9 offset:0
    v_mfma_f32_16x16x32_bf16 v[44:47], v[192:195], v[236:239], v[44:47]
    v_mfma_f32_16x16x32_bf16 v[44:47], v[200:203], v[244:247], v[44:47]
    ds_read_b128 v[148:151], v3 offset:864
    v_mfma_f32_16x16x32_bf16 v[44:47], v[208:211], v[252:255], v[44:47]
    s_waitcnt lgkmcnt(5)
    v_mfma_f32_16x16x32_bf16 v[12:15], v[88:91], v[84:87], v[12:15]
    v_mfma_f32_16x16x32_bf16 v[12:15], v[96:99], v[92:95], v[12:15]
    ds_read_b128 v[152:155], v3 offset:960
    v_mfma_f32_16x16x32_bf16 v[12:15], v[104:107], v[100:103], v[12:15]
    v_mfma_f32_16x16x32_bf16 v[12:15], v[112:115], v[108:111], v[12:15]
    v_mfma_f32_16x16x32_bf16 v[12:15], v[120:123], v[116:119], v[12:15]
    ds_read_b128 v[156:159], v3 offset:1056
    v_mfma_f32_16x16x32_bf16 v[12:15], v[128:131], v[124:127], v[12:15]
    s_waitcnt lgkmcnt(3)
    v_mfma_f32_16x16x32_bf16 v[12:15], v[136:139], v[132:135], v[12:15]
    v_mfma_f32_16x16x32_bf16 v[12:15], v[144:147], v[140:143], v[12:15]
    ds_read_b128 v[160:163], v3 offset:1152
    v_mfma_f32_16x16x32_bf16 v[16:19], v[88:91], v[92:95], v[16:19]
    v_mfma_f32_16x16x32_bf16 v[16:19], v[96:99], v[100:103], v[16:19]
    v_mfma_f32_16x16x32_bf16 v[16:19], v[104:107], v[108:111], v[16:19]
    ds_read_b128 v[164:167], v3 offset:1248
    v_mfma_f32_16x16x32_bf16 v[16:19], v[112:115], v[116:119], v[16:19]
    v_mfma_f32_16x16x32_bf16 v[16:19], v[120:123], v[124:127], v[16:19]
    v_mfma_f32_16x16x32_bf16 v[16:19], v[128:131], v[132:135], v[16:19]
    ds_read_b128 v[168:171], v3 offset:1344
    v_mfma_f32_16x16x32_bf16 v[16:19], v[136:139], v[140:143], v[16:19]
    s_waitcnt lgkmcnt(3)
    v_mfma_f32_16x16x32_bf16 v[16:19], v[144:147], v[148:151], v[16:19]
    v_mfma_f32_16x16x32_bf16 v[20:23], v[88:91], v[100:103], v[20:23]
    ds_read_b128 v[172:175], v3 offset:1440
    v_mfma_f32_16x16x32_bf16 v[20:23], v[96:99], v[108:111], v[20:23]
    v_mfma_f32_16x16x32_bf16 v[20:23], v[104:107], v[116:119], v[20:23]
    v_mfma_f32_16x16x32_bf16 v[20:23], v[112:115], v[124:127], v[20:23]
    ds_read_b128 v[176:179], v3 offset:1536
    v_mfma_f32_16x16x32_bf16 v[20:23], v[120:123], v[132:135], v[20:23]
    v_mfma_f32_16x16x32_bf16 v[20:23], v[128:131], v[140:143], v[20:23]
    v_mfma_f32_16x16x32_bf16 v[20:23], v[136:139], v[148:151], v[20:23]
    ds_read_b128 v[180:183], v6 offset:96
    v_mfma_f32_16x16x32_bf16 v[20:23], v[144:147], v[152:155], v[20:23]
    v_mfma_f32_16x16x32_bf16 v[24:27], v[88:91], v[108:111], v[24:27]
    v_mfma_f32_16x16x32_bf16 v[24:27], v[96:99], v[116:119], v[24:27]
    ds_read_b128 v[184:187], v9 offset:11264
    v_mfma_f32_16x16x32_bf16 v[24:27], v[104:107], v[124:127], v[24:27]
    v_mfma_f32_16x16x32_bf16 v[24:27], v[112:115], v[132:135], v[24:27]
    v_mfma_f32_16x16x32_bf16 v[24:27], v[120:123], v[140:143], v[24:27]
    ds_read_b128 v[188:191], v6 offset:288
    v_mfma_f32_16x16x32_bf16 v[24:27], v[128:131], v[148:151], v[24:27]
    v_mfma_f32_16x16x32_bf16 v[24:27], v[136:139], v[152:155], v[24:27]
    v_mfma_f32_16x16x32_bf16 v[24:27], v[144:147], v[156:159], v[24:27]
    ds_read_b128 v[192:195], v9 offset:10240
    v_mfma_f32_16x16x32_bf16 v[28:31], v[88:91], v[116:119], v[28:31]
    v_mfma_f32_16x16x32_bf16 v[28:31], v[96:99], v[124:127], v[28:31]
    v_mfma_f32_16x16x32_bf16 v[28:31], v[104:107], v[132:135], v[28:31]
    ds_read_b128 v[196:199], v6 offset:480
    v_mfma_f32_16x16x32_bf16 v[28:31], v[112:115], v[140:143], v[28:31]
    v_mfma_f32_16x16x32_bf16 v[28:31], v[120:123], v[148:151], v[28:31]
    v_mfma_f32_16x16x32_bf16 v[28:31], v[128:131], v[152:155], v[28:31]
    ds_read_b128 v[200:203], v9 offset:9216
    v_mfma_f32_16x16x32_bf16 v[28:31], v[136:139], v[156:159], v[28:31]
    s_waitcnt lgkmcnt(3)
    v_mfma_f32_16x16x32_bf16 v[28:31], v[144:147], v[160:163], v[28:31]
    v_mfma_f32_16x16x32_bf16 v[32:35], v[88:91], v[124:127], v[32:35]
    ds_read_b128 v[204:207], v6 offset:672
    v_mfma_f32_16x16x32_bf16 v[32:35], v[96:99], v[132:135], v[32:35]
    v_mfma_f32_16x16x32_bf16 v[32:35], v[104:107], v[140:143], v[32:35]
    v_mfma_f32_16x16x32_bf16 v[32:35], v[112:115], v[148:151], v[32:35]
    ds_read_b128 v[208:211], v9 offset:8192
    v_mfma_f32_16x16x32_bf16 v[32:35], v[120:123], v[152:155], v[32:35]
    v_mfma_f32_16x16x32_bf16 v[32:35], v[128:131], v[156:159], v[32:35]
    v_mfma_f32_16x16x32_bf16 v[32:35], v[136:139], v[160:163], v[32:35]
    ds_read_b128 v[212:215], v6 offset:192
    v_mfma_f32_16x16x32_bf16 v[32:35], v[144:147], v[164:167], v[32:35]
    v_mfma_f32_16x16x32_bf16 v[36:39], v[88:91], v[132:135], v[36:39]
    v_mfma_f32_16x16x32_bf16 v[36:39], v[96:99], v[140:143], v[36:39]
    ds_read_b128 v[216:219], v6 offset:384
    v_mfma_f32_16x16x32_bf16 v[36:39], v[104:107], v[148:151], v[36:39]
    v_mfma_f32_16x16x32_bf16 v[36:39], v[112:115], v[152:155], v[36:39]
    v_mfma_f32_16x16x32_bf16 v[36:39], v[120:123], v[156:159], v[36:39]
    ds_read_b128 v[220:223], v6 offset:576
    v_mfma_f32_16x16x32_bf16 v[36:39], v[128:131], v[160:163], v[36:39]
    v_mfma_f32_16x16x32_bf16 v[36:39], v[136:139], v[164:167], v[36:39]
    v_mfma_f32_16x16x32_bf16 v[36:39], v[144:147], v[168:171], v[36:39]
    ds_read_b128 v[224:227], v6 offset:768
    v_mfma_f32_16x16x32_bf16 v[40:43], v[88:91], v[140:143], v[40:43]
    v_mfma_f32_16x16x32_bf16 v[40:43], v[96:99], v[148:151], v[40:43]
    v_mfma_f32_16x16x32_bf16 v[40:43], v[104:107], v[152:155], v[40:43]
    ds_read_b128 v[228:231], v6 offset:864
    v_mfma_f32_16x16x32_bf16 v[40:43], v[112:115], v[156:159], v[40:43]
    v_mfma_f32_16x16x32_bf16 v[40:43], v[120:123], v[160:163], v[40:43]
    v_mfma_f32_16x16x32_bf16 v[40:43], v[128:131], v[164:167], v[40:43]
    ds_read_b128 v[232:235], v6 offset:960
    v_mfma_f32_16x16x32_bf16 v[40:43], v[136:139], v[168:171], v[40:43]
    v_mfma_f32_16x16x32_bf16 v[40:43], v[144:147], v[172:175], v[40:43]
    v_mfma_f32_16x16x32_bf16 v[44:47], v[88:91], v[148:151], v[44:47]
    ds_read_b128 v[236:239], v6 offset:1056
    v_mfma_f32_16x16x32_bf16 v[44:47], v[96:99], v[152:155], v[44:47]
    v_mfma_f32_16x16x32_bf16 v[44:47], v[104:107], v[156:159], v[44:47]
    v_mfma_f32_16x16x32_bf16 v[44:47], v[112:115], v[160:163], v[44:47]
    ds_read_b128 v[240:243], v6 offset:1152
    v_mfma_f32_16x16x32_bf16 v[44:47], v[120:123], v[164:167], v[44:47]
    v_mfma_f32_16x16x32_bf16 v[44:47], v[128:131], v[168:171], v[44:47]
    v_mfma_f32_16x16x32_bf16 v[44:47], v[136:139], v[172:175], v[44:47]
    ds_read_b128 v[244:247], v6 offset:1248
    v_mfma_f32_16x16x32_bf16 v[44:47], v[144:147], v[176:179], v[44:47]
    v_mfma_f32_16x16x32_bf16 v[12:15], v[184:187], v[180:183], v[12:15]
    s_waitcnt lgkmcnt(3)
    v_mfma_f32_16x16x32_bf16 v[12:15], v[192:195], v[188:191], v[12:15]
    ds_read_b128 v[248:251], v6 offset:1344
    v_mfma_f32_16x16x32_bf16 v[12:15], v[200:203], v[196:199], v[12:15]
    v_mfma_f32_16x16x32_bf16 v[12:15], v[208:211], v[204:207], v[12:15]
    v_mfma_f32_16x16x32_bf16 v[16:19], v[184:187], v[212:215], v[16:19]
    ds_read_b128 v[252:255], v6 offset:1440
    v_mfma_f32_16x16x32_bf16 v[16:19], v[192:195], v[216:219], v[16:19]
    v_mfma_f32_16x16x32_bf16 v[16:19], v[200:203], v[220:223], v[16:19]
    v_mfma_f32_16x16x32_bf16 v[16:19], v[208:211], v[224:227], v[16:19]
    v_mfma_f32_16x16x32_bf16 v[20:23], v[184:187], v[188:191], v[20:23]
    v_mfma_f32_16x16x32_bf16 v[20:23], v[192:195], v[196:199], v[20:23]
    s_waitcnt lgkmcnt(0)
    s_barrier
    v_mfma_f32_16x16x32_bf16 v[20:23], v[200:203], v[204:207], v[20:23]
    ds_read_b128 v[84:87], v4 offset:96
    v_mfma_f32_16x16x32_bf16 v[20:23], v[208:211], v[228:231], v[20:23]
    ds_read_b128 v[88:91], v10 offset:7168
    v_mfma_f32_16x16x32_bf16 v[24:27], v[184:187], v[216:219], v[24:27]
    v_mfma_f32_16x16x32_bf16 v[24:27], v[192:195], v[220:223], v[24:27]
    ds_read_b128 v[92:95], v4 offset:192
    v_mfma_f32_16x16x32_bf16 v[24:27], v[200:203], v[224:227], v[24:27]
    ds_read_b128 v[96:99], v10 offset:6144
    v_mfma_f32_16x16x32_bf16 v[24:27], v[208:211], v[232:235], v[24:27]
    v_mfma_f32_16x16x32_bf16 v[28:31], v[184:187], v[196:199], v[28:31]
    ds_read_b128 v[100:103], v4 offset:288
    v_mfma_f32_16x16x32_bf16 v[28:31], v[192:195], v[204:207], v[28:31]
    ds_read_b128 v[104:107], v10 offset:5120
    v_mfma_f32_16x16x32_bf16 v[28:31], v[200:203], v[228:231], v[28:31]
    v_mfma_f32_16x16x32_bf16 v[28:31], v[208:211], v[236:239], v[28:31]
    ds_read_b128 v[108:111], v4 offset:384
    v_mfma_f32_16x16x32_bf16 v[32:35], v[184:187], v[220:223], v[32:35]
    ds_read_b128 v[112:115], v10 offset:4096
    v_mfma_f32_16x16x32_bf16 v[32:35], v[192:195], v[224:227], v[32:35]
    v_mfma_f32_16x16x32_bf16 v[32:35], v[200:203], v[232:235], v[32:35]
    ds_read_b128 v[116:119], v4 offset:480
    v_mfma_f32_16x16x32_bf16 v[32:35], v[208:211], v[240:243], v[32:35]
    ds_read_b128 v[120:123], v10 offset:3072
    v_mfma_f32_16x16x32_bf16 v[36:39], v[184:187], v[204:207], v[36:39]
    v_mfma_f32_16x16x32_bf16 v[36:39], v[192:195], v[228:231], v[36:39]
    ds_read_b128 v[124:127], v4 offset:576
    v_mfma_f32_16x16x32_bf16 v[36:39], v[200:203], v[236:239], v[36:39]
    ds_read_b128 v[128:131], v10 offset:2048
    v_mfma_f32_16x16x32_bf16 v[36:39], v[208:211], v[244:247], v[36:39]
    v_mfma_f32_16x16x32_bf16 v[40:43], v[184:187], v[224:227], v[40:43]
    ds_read_b128 v[132:135], v4 offset:672
    v_mfma_f32_16x16x32_bf16 v[40:43], v[192:195], v[232:235], v[40:43]
    ds_read_b128 v[136:139], v10 offset:1024
    v_mfma_f32_16x16x32_bf16 v[40:43], v[200:203], v[240:243], v[40:43]
    v_mfma_f32_16x16x32_bf16 v[40:43], v[208:211], v[248:251], v[40:43]
    ds_read_b128 v[140:143], v4 offset:768
    v_mfma_f32_16x16x32_bf16 v[44:47], v[184:187], v[228:231], v[44:47]
    ds_read_b128 v[144:147], v10 offset:0
    v_mfma_f32_16x16x32_bf16 v[44:47], v[192:195], v[236:239], v[44:47]
    v_mfma_f32_16x16x32_bf16 v[44:47], v[200:203], v[244:247], v[44:47]
    ds_read_b128 v[148:151], v4 offset:864
    v_mfma_f32_16x16x32_bf16 v[44:47], v[208:211], v[252:255], v[44:47]
    s_waitcnt lgkmcnt(5)
    v_mfma_f32_16x16x32_bf16 v[12:15], v[88:91], v[84:87], v[12:15]
    v_mfma_f32_16x16x32_bf16 v[12:15], v[96:99], v[92:95], v[12:15]
    ds_read_b128 v[152:155], v4 offset:960
    v_mfma_f32_16x16x32_bf16 v[12:15], v[104:107], v[100:103], v[12:15]
    v_mfma_f32_16x16x32_bf16 v[12:15], v[112:115], v[108:111], v[12:15]
    v_mfma_f32_16x16x32_bf16 v[12:15], v[120:123], v[116:119], v[12:15]
    ds_read_b128 v[156:159], v4 offset:1056
    v_mfma_f32_16x16x32_bf16 v[12:15], v[128:131], v[124:127], v[12:15]
    s_waitcnt lgkmcnt(3)
    v_mfma_f32_16x16x32_bf16 v[12:15], v[136:139], v[132:135], v[12:15]
    v_mfma_f32_16x16x32_bf16 v[12:15], v[144:147], v[140:143], v[12:15]
    ds_read_b128 v[160:163], v4 offset:1152
    v_mfma_f32_16x16x32_bf16 v[16:19], v[88:91], v[92:95], v[16:19]
    v_mfma_f32_16x16x32_bf16 v[16:19], v[96:99], v[100:103], v[16:19]
    v_mfma_f32_16x16x32_bf16 v[16:19], v[104:107], v[108:111], v[16:19]
    ds_read_b128 v[164:167], v4 offset:1248
    v_mfma_f32_16x16x32_bf16 v[16:19], v[112:115], v[116:119], v[16:19]
    v_mfma_f32_16x16x32_bf16 v[16:19], v[120:123], v[124:127], v[16:19]
    v_mfma_f32_16x16x32_bf16 v[16:19], v[128:131], v[132:135], v[16:19]
    ds_read_b128 v[168:171], v4 offset:1344
    v_mfma_f32_16x16x32_bf16 v[16:19], v[136:139], v[140:143], v[16:19]
    s_waitcnt lgkmcnt(3)
    v_mfma_f32_16x16x32_bf16 v[16:19], v[144:147], v[148:151], v[16:19]
    v_mfma_f32_16x16x32_bf16 v[20:23], v[88:91], v[100:103], v[20:23]
    ds_read_b128 v[172:175], v4 offset:1440
    v_mfma_f32_16x16x32_bf16 v[20:23], v[96:99], v[108:111], v[20:23]
    v_mfma_f32_16x16x32_bf16 v[20:23], v[104:107], v[116:119], v[20:23]
    v_mfma_f32_16x16x32_bf16 v[20:23], v[112:115], v[124:127], v[20:23]
    ds_read_b128 v[176:179], v4 offset:1536
    v_mfma_f32_16x16x32_bf16 v[20:23], v[120:123], v[132:135], v[20:23]
    v_mfma_f32_16x16x32_bf16 v[20:23], v[128:131], v[140:143], v[20:23]
    v_mfma_f32_16x16x32_bf16 v[20:23], v[136:139], v[148:151], v[20:23]
    ds_read_b128 v[180:183], v7 offset:96
    v_mfma_f32_16x16x32_bf16 v[20:23], v[144:147], v[152:155], v[20:23]
    v_mfma_f32_16x16x32_bf16 v[24:27], v[88:91], v[108:111], v[24:27]
    v_mfma_f32_16x16x32_bf16 v[24:27], v[96:99], v[116:119], v[24:27]
    ds_read_b128 v[184:187], v10 offset:11264
    v_mfma_f32_16x16x32_bf16 v[24:27], v[104:107], v[124:127], v[24:27]
    v_mfma_f32_16x16x32_bf16 v[24:27], v[112:115], v[132:135], v[24:27]
    v_mfma_f32_16x16x32_bf16 v[24:27], v[120:123], v[140:143], v[24:27]
    ds_read_b128 v[188:191], v7 offset:288
    v_mfma_f32_16x16x32_bf16 v[24:27], v[128:131], v[148:151], v[24:27]
    v_mfma_f32_16x16x32_bf16 v[24:27], v[136:139], v[152:155], v[24:27]
    v_mfma_f32_16x16x32_bf16 v[24:27], v[144:147], v[156:159], v[24:27]
    ds_read_b128 v[192:195], v10 offset:10240
    v_mfma_f32_16x16x32_bf16 v[28:31], v[88:91], v[116:119], v[28:31]
    v_mfma_f32_16x16x32_bf16 v[28:31], v[96:99], v[124:127], v[28:31]
    v_mfma_f32_16x16x32_bf16 v[28:31], v[104:107], v[132:135], v[28:31]
    ds_read_b128 v[196:199], v7 offset:480
    v_mfma_f32_16x16x32_bf16 v[28:31], v[112:115], v[140:143], v[28:31]
    v_mfma_f32_16x16x32_bf16 v[28:31], v[120:123], v[148:151], v[28:31]
    v_mfma_f32_16x16x32_bf16 v[28:31], v[128:131], v[152:155], v[28:31]
    ds_read_b128 v[200:203], v10 offset:9216
    v_mfma_f32_16x16x32_bf16 v[28:31], v[136:139], v[156:159], v[28:31]
    s_waitcnt lgkmcnt(3)
    v_mfma_f32_16x16x32_bf16 v[28:31], v[144:147], v[160:163], v[28:31]
    v_mfma_f32_16x16x32_bf16 v[32:35], v[88:91], v[124:127], v[32:35]
    ds_read_b128 v[204:207], v7 offset:672
    v_mfma_f32_16x16x32_bf16 v[32:35], v[96:99], v[132:135], v[32:35]
    v_mfma_f32_16x16x32_bf16 v[32:35], v[104:107], v[140:143], v[32:35]
    v_mfma_f32_16x16x32_bf16 v[32:35], v[112:115], v[148:151], v[32:35]
    ds_read_b128 v[208:211], v10 offset:8192
    v_mfma_f32_16x16x32_bf16 v[32:35], v[120:123], v[152:155], v[32:35]
    v_mfma_f32_16x16x32_bf16 v[32:35], v[128:131], v[156:159], v[32:35]
    v_mfma_f32_16x16x32_bf16 v[32:35], v[136:139], v[160:163], v[32:35]
    ds_read_b128 v[212:215], v7 offset:192
    v_mfma_f32_16x16x32_bf16 v[32:35], v[144:147], v[164:167], v[32:35]
    v_mfma_f32_16x16x32_bf16 v[36:39], v[88:91], v[132:135], v[36:39]
    v_mfma_f32_16x16x32_bf16 v[36:39], v[96:99], v[140:143], v[36:39]
    ds_read_b128 v[216:219], v7 offset:384
    v_mfma_f32_16x16x32_bf16 v[36:39], v[104:107], v[148:151], v[36:39]
    v_mfma_f32_16x16x32_bf16 v[36:39], v[112:115], v[152:155], v[36:39]
    v_mfma_f32_16x16x32_bf16 v[36:39], v[120:123], v[156:159], v[36:39]
    ds_read_b128 v[220:223], v7 offset:576
    v_mfma_f32_16x16x32_bf16 v[36:39], v[128:131], v[160:163], v[36:39]
    v_mfma_f32_16x16x32_bf16 v[36:39], v[136:139], v[164:167], v[36:39]
    v_mfma_f32_16x16x32_bf16 v[36:39], v[144:147], v[168:171], v[36:39]
    ds_read_b128 v[224:227], v7 offset:768
    v_mfma_f32_16x16x32_bf16 v[40:43], v[88:91], v[140:143], v[40:43]
    v_mfma_f32_16x16x32_bf16 v[40:43], v[96:99], v[148:151], v[40:43]
    v_mfma_f32_16x16x32_bf16 v[40:43], v[104:107], v[152:155], v[40:43]
    ds_read_b128 v[228:231], v7 offset:864
    v_mfma_f32_16x16x32_bf16 v[40:43], v[112:115], v[156:159], v[40:43]
    v_mfma_f32_16x16x32_bf16 v[40:43], v[120:123], v[160:163], v[40:43]
    v_mfma_f32_16x16x32_bf16 v[40:43], v[128:131], v[164:167], v[40:43]
    ds_read_b128 v[232:235], v7 offset:960
    v_mfma_f32_16x16x32_bf16 v[40:43], v[136:139], v[168:171], v[40:43]
    v_mfma_f32_16x16x32_bf16 v[40:43], v[144:147], v[172:175], v[40:43]
    v_mfma_f32_16x16x32_bf16 v[44:47], v[88:91], v[148:151], v[44:47]
    ds_read_b128 v[236:239], v7 offset:1056
    v_mfma_f32_16x16x32_bf16 v[44:47], v[96:99], v[152:155], v[44:47]
    v_mfma_f32_16x16x32_bf16 v[44:47], v[104:107], v[156:159], v[44:47]
    v_mfma_f32_16x16x32_bf16 v[44:47], v[112:115], v[160:163], v[44:47]
    ds_read_b128 v[240:243], v7 offset:1152
    v_mfma_f32_16x16x32_bf16 v[44:47], v[120:123], v[164:167], v[44:47]
    v_mfma_f32_16x16x32_bf16 v[44:47], v[128:131], v[168:171], v[44:47]
    v_mfma_f32_16x16x32_bf16 v[44:47], v[136:139], v[172:175], v[44:47]
    ds_read_b128 v[244:247], v7 offset:1248
    v_mfma_f32_16x16x32_bf16 v[44:47], v[144:147], v[176:179], v[44:47]
    v_mfma_f32_16x16x32_bf16 v[12:15], v[184:187], v[180:183], v[12:15]
    s_waitcnt lgkmcnt(3)
    v_mfma_f32_16x16x32_bf16 v[12:15], v[192:195], v[188:191], v[12:15]
    ds_read_b128 v[248:251], v7 offset:1344
    v_mfma_f32_16x16x32_bf16 v[12:15], v[200:203], v[196:199], v[12:15]
    v_mfma_f32_16x16x32_bf16 v[48:51], v[208:211], v[204:207], v[12:15]
    v_mfma_f32_16x16x32_bf16 v[16:19], v[184:187], v[212:215], v[16:19]
    ds_read_b128 v[252:255], v7 offset:1440
    v_mfma_f32_16x16x32_bf16 v[16:19], v[192:195], v[216:219], v[16:19]
    v_mfma_f32_16x16x32_bf16 v[16:19], v[200:203], v[220:223], v[16:19]
    v_mfma_f32_16x16x32_bf16 v[52:55], v[208:211], v[224:227], v[16:19]
    v_mfma_f32_16x16x32_bf16 v[20:23], v[184:187], v[188:191], v[20:23]
    v_mfma_f32_16x16x32_bf16 v[20:23], v[192:195], v[196:199], v[20:23]
    s_waitcnt lgkmcnt(0)
    s_barrier
    v_mfma_f32_16x16x32_bf16 v[20:23], v[200:203], v[204:207], v[20:23]
    ds_read_b128 v[84:87], v2 offset:96
    v_mfma_f32_16x16x32_bf16 v[56:59], v[208:211], v[228:231], v[20:23]
    ds_read_b128 v[88:91], v8 offset:7168
    v_mfma_f32_16x16x32_bf16 v[24:27], v[184:187], v[216:219], v[24:27]
    ds_write_b128 v1, v[48:51] offset:0
    v_mfma_f32_16x16x32_bf16 v[24:27], v[192:195], v[220:223], v[24:27]
    ds_read_b128 v[92:95], v2 offset:192
    v_mfma_f32_16x16x32_bf16 v[24:27], v[200:203], v[224:227], v[24:27]
    ds_read_b128 v[96:99], v8 offset:6144
    v_mfma_f32_16x16x32_bf16 v[60:63], v[208:211], v[232:235], v[24:27]
    v_mfma_f32_16x16x32_bf16 v[28:31], v[184:187], v[196:199], v[28:31]
    ds_read_b128 v[100:103], v2 offset:288
    v_mfma_f32_16x16x32_bf16 v[28:31], v[192:195], v[204:207], v[28:31]
    ds_read_b128 v[104:107], v8 offset:5120
    v_mfma_f32_16x16x32_bf16 v[28:31], v[200:203], v[228:231], v[28:31]
    ds_write_b128 v1, v[52:55] offset:1024
    v_mfma_f32_16x16x32_bf16 v[64:67], v[208:211], v[236:239], v[28:31]
    ds_read_b128 v[108:111], v2 offset:384
    v_mfma_f32_16x16x32_bf16 v[32:35], v[184:187], v[220:223], v[32:35]
    ds_read_b128 v[112:115], v8 offset:4096
    v_mfma_f32_16x16x32_bf16 v[32:35], v[192:195], v[224:227], v[32:35]
    v_mfma_f32_16x16x32_bf16 v[32:35], v[200:203], v[232:235], v[32:35]
    ds_read_b128 v[116:119], v2 offset:480
    v_mfma_f32_16x16x32_bf16 v[68:71], v[208:211], v[240:243], v[32:35]
    ds_read_b128 v[120:123], v8 offset:3072
    v_mfma_f32_16x16x32_bf16 v[36:39], v[184:187], v[204:207], v[36:39]
    ds_write_b128 v1, v[56:59] offset:2048
    v_mfma_f32_16x16x32_bf16 v[36:39], v[192:195], v[228:231], v[36:39]
    ds_read_b128 v[124:127], v2 offset:576
    v_mfma_f32_16x16x32_bf16 v[36:39], v[200:203], v[236:239], v[36:39]
    ds_read_b128 v[128:131], v8 offset:2048
    v_mfma_f32_16x16x32_bf16 v[72:75], v[208:211], v[244:247], v[36:39]
    v_mfma_f32_16x16x32_bf16 v[40:43], v[184:187], v[224:227], v[40:43]
    ds_read_b128 v[132:135], v2 offset:672
    v_mfma_f32_16x16x32_bf16 v[40:43], v[192:195], v[232:235], v[40:43]
    ds_read_b128 v[136:139], v8 offset:1024
    v_mfma_f32_16x16x32_bf16 v[40:43], v[200:203], v[240:243], v[40:43]
    ds_write_b128 v1, v[60:63] offset:3072
    v_mfma_f32_16x16x32_bf16 v[76:79], v[208:211], v[248:251], v[40:43]
    ds_read_b128 v[140:143], v2 offset:768
    v_mfma_f32_16x16x32_bf16 v[44:47], v[184:187], v[228:231], v[44:47]
    ds_read_b128 v[144:147], v8 offset:0
    s_sub_u32 s39, s39, 1
    v_mfma_f32_16x16x32_bf16 v[44:47], v[192:195], v[236:239], v[44:47]
    s_cmp_lg_u32 s39, 0
    v_mfma_f32_16x16x32_bf16 v[44:47], v[200:203], v[244:247], v[44:47]
    ds_read_b128 v[148:151], v2 offset:864
    v_mfma_f32_16x16x32_bf16 v[80:83], v[208:211], v[252:255], v[44:47]
    ds_write_b128 v1, v[64:67] offset:4096
    s_cbranch_scc1 L_loop
    s_waitcnt lgkmcnt(0)
    s_mov_b32 s46, 0xbf317218
    s_mov_b32 s42, 0x3a38aa3b
    s_mov_b32 s43, 0x41f00000
    v_and_b32 v100, 63, v0
    v_lshlrev_b32 v101, 2, v100
    s_add_u32 s63, s62, 13824
    v_min_f32 v104, s43, v48
    v_min_f32 v105, s43, v49
    v_exp_f32 v50, v50
    v_exp_f32 v51, v51
    v_exp_f32 v104, v104
    v_exp_f32 v105, v105
    v_cmp_gt_f32 s[48:49], s42, abs(v48)
    v_cmp_gt_f32 s[50:51], s42, abs(v49)
    v_add_f32 v106, 1.0, v104
    v_add_f32 v107, 1.0, v105
    v_mul_f32 v48, s46, v48
    v_mul_f32 v49, s46, v49
    v_fmac_f32 v106, v106, v50
    v_fmac_f32 v107, v107, v51
    v_sub_f32 v104, 1.0, v104
    v_sub_f32 v105, 1.0, v105
    v_rcp_f32 v106, v106
    v_rcp_f32 v107, v107
    v_cndmask_b32 v104, v104, v48, s[48:49]
    v_cndmask_b32 v105, v105, v49, s[50:51]
    v_mul_f32 v104, v104, v106
    v_mul_f32 v105, v105, v107
    v_cvt_pk_bf16_f32 v112, v104, v105
    buffer_store_dword v112, v101, s[20:23], s63 offen sc1
    s_add_u32 s63, s62, 32256
    v_min_f32 v108, s43, v52
    v_min_f32 v109, s43, v53
    v_exp_f32 v54, v54
    v_exp_f32 v55, v55
    v_exp_f32 v108, v108
    v_exp_f32 v109, v109
    v_cmp_gt_f32 s[48:49], s42, abs(v52)
    v_cmp_gt_f32 s[50:51], s42, abs(v53)
    v_add_f32 v110, 1.0, v108
    v_add_f32 v111, 1.0, v109
    v_mul_f32 v52, s46, v52
    v_mul_f32 v53, s46, v53
    v_fmac_f32 v110, v110, v54
    v_fmac_f32 v111, v111, v55
    v_sub_f32 v108, 1.0, v108
    v_sub_f32 v109, 1.0, v109
    v_rcp_f32 v110, v110
    v_rcp_f32 v111, v111
    v_cndmask_b32 v108, v108, v52, s[48:49]
    v_cndmask_b32 v109, v109, v53, s[50:51]
    v_mul_f32 v108, v108, v110
    v_mul_f32 v109, v109, v111
    v_cvt_pk_bf16_f32 v113, v108, v109
    buffer_store_dword v113, v101, s[20:23], s63 offen sc1
    s_add_u32 s63, s62, 50688
    v_min_f32 v104, s43, v56
    v_min_f32 v105, s43, v57
    v_exp_f32 v58, v58
    v_exp_f32 v59, v59
    v_exp_f32 v104, v104
    v_exp_f32 v105, v105
    v_cmp_gt_f32 s[48:49], s42, abs(v56)
    v_cmp_gt_f32 s[50:51], s42, abs(v57)
    v_add_f32 v106, 1.0, v104
    v_add_f32 v107, 1.0, v105
    v_mul_f32 v56, s46, v56
    v_mul_f32 v57, s46, v57
    v_fmac_f32 v106, v106, v58
    v_fmac_f32 v107, v107, v59
    v_sub_f32 v104, 1.0, v104
    v_sub_f32 v105, 1.0, v105
    v_rcp_f32 v106, v106
    v_rcp_f32 v107, v107
    v_cndmask_b32 v104, v104, v56, s[48:49]
    v_cndmask_b32 v105, v105, v57, s[50:51]
    v_mul_f32 v104, v104, v106
    v_mul_f32 v105, v105, v107
    v_cvt_pk_bf16_f32 v114, v104, v105
    buffer_store_dword v114, v101, s[20:23], s63 offen sc1
    s_add_u32 s63, s62, 69120
    v_min_f32 v108, s43, v60
    v_min_f32 v109, s43, v61
    v_exp_f32 v62, v62
    v_exp_f32 v63, v63
    v_exp_f32 v108, v108
    v_exp_f32 v109, v109
    v_cmp_gt_f32 s[48:49], s42, abs(v60)
    v_cmp_gt_f32 s[50:51], s42, abs(v61)
    v_add_f32 v110, 1.0, v108
    v_add_f32 v111, 1.0, v109
    v_mul_f32 v60, s46, v60
    v_mul_f32 v61, s46, v61
    v_fmac_f32 v110, v110, v62
    v_fmac_f32 v111, v111, v63
    v_sub_f32 v108, 1.0, v108
    v_sub_f32 v109, 1.0, v109
    v_rcp_f32 v110, v110
    v_rcp_f32 v111, v111
    v_cndmask_b32 v108, v108, v60, s[48:49]
    v_cndmask_b32 v109, v109, v61, s[50:51]
    v_mul_f32 v108, v108, v110
    v_mul_f32 v109, v109, v111
    v_cvt_pk_bf16_f32 v115, v108, v109
    buffer_store_dword v115, v101, s[20:23], s63 offen sc1
    s_add_u32 s63, s62, 87552
    v_min_f32 v104, s43, v64
    v_min_f32 v105, s43, v65
    v_exp_f32 v66, v66
    v_exp_f32 v67, v67
    v_exp_f32 v104, v104
    v_exp_f32 v105, v105
    v_cmp_gt_f32 s[48:49], s42, abs(v64)
    v_cmp_gt_f32 s[50:51], s42, abs(v65)
    v_add_f32 v106, 1.0, v104
    v_add_f32 v107, 1.0, v105
    v_mul_f32 v64, s46, v64
    v_mul_f32 v65, s46, v65
    v_fmac_f32 v106, v106, v66
    v_fmac_f32 v107, v107, v67
    v_sub_f32 v104, 1.0, v104
    v_sub_f32 v105, 1.0, v105
    v_rcp_f32 v106, v106
    v_rcp_f32 v107, v107
    v_cndmask_b32 v104, v104, v64, s[48:49]
    v_cndmask_b32 v105, v105, v65, s[50:51]
    v_mul_f32 v104, v104, v106
    v_mul_f32 v105, v105, v107
    v_cvt_pk_bf16_f32 v116, v104, v105
    buffer_store_dword v116, v101, s[20:23], s63 offen sc1
    s_add_u32 s63, s62, 105984
    v_min_f32 v108, s43, v68
    v_min_f32 v109, s43, v69
    v_exp_f32 v70, v70
    v_exp_f32 v71, v71
    v_exp_f32 v108, v108
    v_exp_f32 v109, v109
    v_cmp_gt_f32 s[48:49], s42, abs(v68)
    v_cmp_gt_f32 s[50:51], s42, abs(v69)
    v_add_f32 v110, 1.0, v108
    v_add_f32 v111, 1.0, v109
    v_mul_f32 v68, s46, v68
    v_mul_f32 v69, s46, v69
    v_fmac_f32 v110, v110, v70
    v_fmac_f32 v111, v111, v71
    v_sub_f32 v108, 1.0, v108
    v_sub_f32 v109, 1.0, v109
    v_rcp_f32 v110, v110
    v_rcp_f32 v111, v111
    v_cndmask_b32 v108, v108, v68, s[48:49]
    v_cndmask_b32 v109, v109, v69, s[50:51]
    v_mul_f32 v108, v108, v110
    v_mul_f32 v109, v109, v111
    v_cvt_pk_bf16_f32 v117, v108, v109
    buffer_store_dword v117, v101, s[20:23], s63 offen sc1
    s_add_u32 s63, s62, 124416
    v_min_f32 v104, s43, v72
    v_min_f32 v105, s43, v73
    v_exp_f32 v74, v74
    v_exp_f32 v75, v75
    v_exp_f32 v104, v104
    v_exp_f32 v105, v105
    v_cmp_gt_f32 s[48:49], s42, abs(v72)
    v_cmp_gt_f32 s[50:51], s42, abs(v73)
    v_add_f32 v106, 1.0, v104
    v_add_f32 v107, 1.0, v105
    v_mul_f32 v72, s46, v72
    v_mul_f32 v73, s46, v73
    v_fmac_f32 v106, v106, v74
    v_fmac_f32 v107, v107, v75
    v_sub_f32 v104, 1.0, v104
    v_sub_f32 v105, 1.0, v105
    v_rcp_f32 v106, v106
    v_rcp_f32 v107, v107
    v_cndmask_b32 v104, v104, v72, s[48:49]
    v_cndmask_b32 v105, v105, v73, s[50:51]
    v_mul_f32 v104, v104, v106
    v_mul_f32 v105, v105, v107
    v_cvt_pk_bf16_f32 v118, v104, v105
    buffer_store_dword v118, v101, s[20:23], s63 offen sc1
    s_add_u32 s63, s62, 142848
    v_min_f32 v108, s43, v76
    v_min_f32 v109, s43, v77
    v_exp_f32 v78, v78
    v_exp_f32 v79, v79
    v_exp_f32 v108, v108
    v_exp_f32 v109, v109
    v_cmp_gt_f32 s[48:49], s42, abs(v76)
    v_cmp_gt_f32 s[50:51], s42, abs(v77)
    v_add_f32 v110, 1.0, v108
    v_add_f32 v111, 1.0, v109
    v_mul_f32 v76, s46, v76
    v_mul_f32 v77, s46, v77
    v_fmac_f32 v110, v110, v78
    v_fmac_f32 v111, v111, v79
    v_sub_f32 v108, 1.0, v108
    v_sub_f32 v109, 1.0, v109
    v_rcp_f32 v110, v110
    v_rcp_f32 v111, v111
    v_cndmask_b32 v108, v108, v76, s[48:49]
    v_cndmask_b32 v109, v109, v77, s[50:51]
    v_mul_f32 v108, v108, v110
    v_mul_f32 v109, v109, v111
    v_cvt_pk_bf16_f32 v119, v108, v109
    buffer_store_dword v119, v101, s[20:23], s63 offen sc1
    s_add_u32 s63, s62, 161280
    v_min_f32 v104, s43, v80
    v_min_f32 v105, s43, v81
    v_exp_f32 v82, v82
    v_exp_f32 v83, v83
    v_exp_f32 v104, v104
    v_exp_f32 v105, v105
    v_cmp_gt_f32 s[48:49], s42, abs(v80)
    v_cmp_gt_f32 s[50:51], s42, abs(v81)
    v_add_f32 v106, 1.0, v104
    v_add_f32 v107, 1.0, v105
    v_mul_f32 v80, s46, v80
    v_mul_f32 v81, s46, v81
    v_fmac_f32 v106, v106, v82
    v_fmac_f32 v107, v107, v83
    v_sub_f32 v104, 1.0, v104
    v_sub_f32 v105, 1.0, v105
    v_rcp_f32 v106, v106
    v_rcp_f32 v107, v107
    v_cndmask_b32 v104, v104, v80, s[48:49]
    v_cndmask_b32 v105, v105, v81, s[50:51]
    v_mul_f32 v104, v104, v106
    v_mul_f32 v105, v105, v107
    v_cvt_pk_bf16_f32 v120, v104, v105
    buffer_store_dword v120, v101, s[20:23], s63 offen sc1
    s_branch L_fin
L_helper:
    v_mov_b32 v3, v101
    v_add_u32 v13, 4096, v101
    v_add_u32 v6, 4096, v6
    v_add_u32 v7, 4096, v7
    s_cmp_eq_u32 s26, 7
    s_cselect_b64 vcc, -1, 0
    v_cndmask_b32 v6, v13, v6, vcc
    v_cndmask_b32 v7, v13, v7, vcc
    s_add_u32 s38, s34, 106496
    v_add_u32 v4, s38, v101
    s_add_u32 s38, s35, 135168
    v_add_u32 v5, s38, v101
    s_cmp_eq_u32 s26, 4
    s_cbranch_scc1 L_h4
    v_mov_b32 v36, 2130706432
    v_mov_b32 v12, 2130706432
    s_branch L_h5
L_h4:
    s_mov_b32 s31, 0
L_tagh:
    buffer_load_dwordx2 v[24:25], v37, s[16:19], 0 offen sc1
    s_add_u32 s31, s31, 1
    s_cmp_gt_u32 s31, 400000
    s_cbranch_scc1 L_tagdh
    s_waitcnt vmcnt(0)
    v_readfirstlane_b32 s92, v24
    v_readfirstlane_b32 s93, v25
    s_nop 3
    s_cmp_eq_u32 s92, 0
    s_cbranch_scc1 L_tagh
L_tagdh:
L_h5:
    v_mov_b32 v38, s92
    v_mov_b32 v39, s93
    s_add_u32 s36, s36, 195072
    s_add_u32 s37, s37, 24576
    s_barrier
    s_add_u32 m0, s34, 53248
    s_nop 0
    buffer_load_dwordx4 v3, s[20:23], s36 offen offset:0 sc1 lds
    s_add_u32 m0, s34, 53248
    s_nop 0
    buffer_load_dwordx4 v3, s[20:23], s36 offen offset:1024 sc1 lds
    s_add_u32 m0, s34, 53248
    s_nop 0
    buffer_load_dwordx4 v3, s[20:23], s36 offen offset:2048 sc1 lds
    s_add_u32 m0, s34, 53248
    s_nop 0
    buffer_load_dwordx4 v3, s[20:23], s36 offen offset:3072 sc1 lds
    s_add_u32 m0, s34, 57344
    s_nop 0
    buffer_load_dwordx4 v13, s[20:23], s36 offen offset:0 sc1 lds
    s_add_u32 m0, s34, 57344
    s_nop 0
    buffer_load_dwordx4 v6, s[20:23], s36 offen offset:1024 sc1 lds
    s_add_u32 m0, s34, 57344
    s_nop 0
    buffer_load_dwordx4 v7, s[20:23], s36 offen offset:2048 sc1 lds
    s_add_u32 s36, s36, 195072
    s_add_u32 m0, s35, 81920
    s_nop 0
    buffer_load_dwordx4 v3, s[20:23], s37 offen offset:0 sc1 lds
    s_add_u32 m0, s35, 81920
    s_nop 0
    buffer_load_dwordx4 v3, s[20:23], s37 offen offset:1024 sc1 lds
    s_add_u32 m0, s35, 81920
    s_nop 0
    buffer_load_dwordx4 v3, s[20:23], s37 offen offset:2048 sc1 lds
    s_add_u32 m0, s35, 81920
    s_nop 0
    buffer_load_dwordx4 v3, s[20:23], s37 offen offset:3072 sc1 lds
    s_add_u32 m0, s35, 86016
    s_nop 0
    buffer_load_dwordx4 v13, s[20:23], s37 offen offset:0 sc1 lds
    s_add_u32 m0, s35, 86016
    s_nop 0
    buffer_load_dwordx4 v13, s[20:23], s37 offen offset:1024 sc1 lds
    s_add_u32 s37, s37, 24576
    s_mov_b32 s40, 0x42b3cc07
    s_mov_b32 s41, 0x00000000
    s_mov_b32 s42, 0x40e38e39
    s_mov_b32 s43, 0xc23a74c5
    s_mov_b32 s44, 0x4133cc07
    s_mov_b32 s45, 0xc097b426
    s_mov_b32 s46, 0x405517bc
    s_mov_b32 s47, 0x00000000
    s_mov_b32 s48, 0x4017b426
    s_mov_b32 s49, 0xbfebbdb3
    s_mov_b32 s50, 0x3f8b7469
    s_mov_b32 s51, 0xbfdf9038
    s_mov_b32 s52, 0x3eb52fb0
    s_mov_b32 s53, 0x00000000
    s_mov_b32 s54, 0x3f8fb824
    s_mov_b32 s55, 0xbe352fb0
    s_mov_b32 s56, 0x3ea15e79
    s_mov_b32 s57, 0xbf0fb824
    s_barrier
    buffer_store_dwordx4 v[184:187], v32, s[20:23], 0 offen sc1
    v_add_u32 v32, s96, v32
    buffer_store_dwordx4 v[188:191], v33, s[20:23], 0 offen sc1
    v_add_u32 v33, s97, v33
    buffer_store_dwordx4 v[192:195], v34, s[20:23], 0 offen sc1
    v_add_u32 v34, s98, v34
    buffer_store_dwordx4 v[196:199], v35, s[20:23], 0 offen sc1
    v_add_u32 v35, s99, v35
    s_barrier
    s_add_u32 m0, s34, 106496
    s_nop 0
    buffer_load_dwordx4 v3, s[20:23], s36 offen offset:0 sc1 lds
    s_add_u32 m0, s34, 106496
    s_nop 0
    buffer_load_dwordx4 v3, s[20:23], s36 offen offset:1024 sc1 lds
    s_add_u32 m0, s34, 106496
    s_nop 0
    buffer_load_dwordx4 v3, s[20:23], s36 offen offset:2048 sc1 lds
    s_add_u32 m0, s34, 106496
    s_nop 0
    buffer_load_dwordx4 v3, s[20:23], s36 offen offset:3072 sc1 lds
    s_add_u32 m0, s34, 110592
    s_nop 0
    buffer_load_dwordx4 v13, s[20:23], s36 offen offset:0 sc1 lds
    s_add_u32 m0, s34, 110592
    s_nop 0
    buffer_load_dwordx4 v6, s[20:23], s36 offen offset:1024 sc1 lds
    s_add_u32 m0, s34, 110592
    s_nop 0
    buffer_load_dwordx4 v7, s[20:23], s36 offen offset:2048 sc1 lds
    s_add_u32 s36, s36, 195072
    s_waitcnt vmcnt(7)
    s_barrier
    s_lshl_b32 s30, s2, 3
    s_add_u32 s30, s30, 30324992
    s_mov_b64 exec, 1
    buffer_store_dwordx2 v[38:39], v12, s[20:23], s30 offen sc1
    s_mov_b64 exec, -1
    s_add_u32 m0, s35, 135168
    s_nop 0
    buffer_load_dwordx4 v3, s[20:23], s37 offen offset:0 sc1 lds
    s_add_u32 m0, s35, 135168
    s_nop 0
    buffer_load_dwordx4 v3, s[20:23], s37 offen offset:1024 sc1 lds
    s_add_u32 m0, s35, 135168
    s_nop 0
    buffer_load_dwordx4 v3, s[20:23], s37 offen offset:2048 sc1 lds
    s_add_u32 m0, s35, 135168
    s_nop 0
    buffer_load_dwordx4 v3, s[20:23], s37 offen offset:3072 sc1 lds
    s_add_u32 m0, s35, 139264
    s_nop 0
    buffer_load_dwordx4 v13, s[20:23], s37 offen offset:0 sc1 lds
    s_add_u32 m0, s35, 139264
    s_nop 0
    buffer_load_dwordx4 v13, s[20:23], s37 offen offset:1024 sc1 lds
    s_add_u32 s37, s37, 24576
    s_add_u32 m0, s34, 0
    s_nop 0
    buffer_load_dwordx4 v3, s[20:23], s36 offen offset:0 sc1 lds
    s_add_u32 m0, s34, 0
    s_nop 0
    buffer_load_dwordx4 v3, s[20:23], s36 offen offset:1024 sc1 lds
    s_add_u32 m0, s34, 0
    s_nop 0
    buffer_load_dwordx4 v3, s[20:23], s36 offen offset:2048 sc1 lds
    s_add_u32 m0, s34, 0
    s_nop 0
    buffer_load_dwordx4 v3, s[20:23], s36 offen offset:3072 sc1 lds
    s_add_u32 m0, s34, 4096
    s_nop 0
    buffer_load_dwordx4 v13, s[20:23], s36 offen offset:0 sc1 lds
    s_add_u32 m0, s34, 4096
    s_nop 0
    buffer_load_dwordx4 v6, s[20:23], s36 offen offset:1024 sc1 lds
    s_add_u32 m0, s34, 4096
    s_nop 0
    buffer_load_dwordx4 v7, s[20:23], s36 offen offset:2048 sc1 lds
    s_add_u32 s36, s36, 195072
    s_add_u32 m0, s35, 28672
    s_nop 0
    buffer_load_dwordx4 v3, s[20:23], s37 offen offset:0 sc1 lds
    s_add_u32 m0, s35, 28672
    s_nop 0
    buffer_load_dwordx4 v3, s[20:23], s37 offen offset:1024 sc1 lds
    s_add_u32 m0, s35, 28672
    s_nop 0
    buffer_load_dwordx4 v3, s[20:23], s37 offen offset:2048 sc1 lds
    s_add_u32 m0, s35, 28672
    s_nop 0
    buffer_load_dwordx4 v3, s[20:23], s37 offen offset:3072 sc1 lds
    s_add_u32 m0, s35, 32768
    s_nop 0
    buffer_load_dwordx4 v13, s[20:23], s37 offen offset:0 sc1 lds
    s_add_u32 m0, s35, 32768
    s_nop 0
    buffer_load_dwordx4 v13, s[20:23], s37 offen offset:1024 sc1 lds
    s_add_u32 s37, s37, 24576
    s_waitcnt vmcnt(13)
    s_barrier
    buffer_store_dwordx4 v[200:203], v32, s[20:23], 0 offen sc1
    v_add_u32 v32, s96, v32
    buffer_store_dwordx4 v[204:207], v33, s[20:23], 0 offen sc1
    v_add_u32 v33, s97, v33
    buffer_store_dwordx4 v[208:211], v34, s[20:23], 0 offen sc1
    v_add_u32 v34, s98, v34
    buffer_store_dwordx4 v[212:215], v35, s[20:23], 0 offen sc1
    v_add_u32 v35, s99, v35
    s_add_u32 m0, s34, 53248
    s_nop 0
    buffer_load_dwordx4 v3, s[20:23], s36 offen offset:0 sc1 lds
    s_add_u32 m0, s34, 53248
    s_nop 0
    buffer_load_dwordx4 v3, s[20:23], s36 offen offset:1024 sc1 lds
    s_add_u32 m0, s34, 53248
    s_nop 0
    buffer_load_dwordx4 v3, s[20:23], s36 offen offset:2048 sc1 lds
    s_add_u32 m0, s34, 53248
    s_nop 0
    buffer_load_dwordx4 v3, s[20:23], s36 offen offset:3072 sc1 lds
    s_add_u32 m0, s34, 57344
    s_nop 0
    buffer_load_dwordx4 v13, s[20:23], s36 offen offset:0 sc1 lds
    s_add_u32 m0, s34, 57344
    s_nop 0
    buffer_load_dwordx4 v6, s[20:23], s36 offen offset:1024 sc1 lds
    s_add_u32 m0, s34, 57344
    s_nop 0
    buffer_load_dwordx4 v7, s[20:23], s36 offen offset:2048 sc1 lds
    s_add_u32 s36, s36, 195072
    s_add_u32 m0, s35, 81920
    s_nop 0
    buffer_load_dwordx4 v3, s[20:23], s37 offen offset:0 sc1 lds
    s_add_u32 m0, s35, 81920
    s_nop 0
    buffer_load_dwordx4 v3, s[20:23], s37 offen offset:1024 sc1 lds
    s_add_u32 m0, s35, 81920
    s_nop 0
    buffer_load_dwordx4 v3, s[20:23], s37 offen offset:2048 sc1 lds
    s_add_u32 m0, s35, 81920
    s_nop 0
    buffer_load_dwordx4 v3, s[20:23], s37 offen offset:3072 sc1 lds
    s_add_u32 m0, s35, 86016
    s_nop 0
    buffer_load_dwordx4 v13, s[20:23], s37 offen offset:0 sc1 lds
    s_add_u32 m0, s35, 86016
    s_nop 0
    buffer_load_dwordx4 v13, s[20:23], s37 offen offset:1024 sc1 lds
    s_add_u32 s37, s37, 24576
    s_waitcnt vmcnt(17)
    s_barrier
    s_mov_b32 s30, 30324992
    buffer_load_dwordx4 v[24:27], v36, s[20:23], s30 offen sc1
    buffer_load_dwordx4 v[28:31], v36, s[20:23], s30 offen offset:16 sc1
    buffer_store_dwordx4 v[216:219], v32, s[20:23], 0 offen sc1
    v_add_u32 v32, s96, v32
    buffer_store_dwordx4 v[220:223], v33, s[20:23], 0 offen sc1
    v_add_u32 v33, s97, v33
    buffer_store_dwordx4 v[224:227], v34, s[20:23], 0 offen sc1
    v_add_u32 v34, s98, v34
    buffer_store_dwordx4 v[228:231], v35, s[20:23], 0 offen sc1
    v_add_u32 v35, s99, v35
    s_barrier
    ds_read_b128 v[148:151], v4 offset:0
    ds_read_b128 v[152:155], v4 offset:1024
    ds_read_b128 v[156:159], v4 offset:2048
    ds_read_b128 v[160:163], v4 offset:3072
    ds_read_b128 v[164:167], v4 offset:4096
    ds_read_b128 v[168:171], v4 offset:5120
    ds_read_b128 v[172:175], v4 offset:6144
    ds_read_b128 v[176:179], v5 offset:0
    ds_read_b128 v[180:183], v5 offset:1024
    s_waitcnt lgkmcnt(0)
    s_add_u32 m0, s34, 106496
    s_nop 0
    buffer_load_dwordx4 v3, s[20:23], s36 offen offset:0 sc1 lds
    s_add_u32 m0, s34, 106496
    s_nop 0
    buffer_load_dwordx4 v3, s[20:23], s36 offen offset:1024 sc1 lds
    s_add_u32 m0, s34, 106496
    s_nop 0
    buffer_load_dwordx4 v3, s[20:23], s36 offen offset:2048 sc1 lds
    s_add_u32 m0, s34, 106496
    s_nop 0
    buffer_load_dwordx4 v3, s[20:23], s36 offen offset:3072 sc1 lds
    s_add_u32 m0, s34, 110592
    s_nop 0
    buffer_load_dwordx4 v13, s[20:23], s36 offen offset:0 sc1 lds
    s_add_u32 m0, s34, 110592
    s_nop 0
    buffer_load_dwordx4 v6, s[20:23], s36 offen offset:1024 sc1 lds
    s_add_u32 m0, s34, 110592
    s_nop 0
    buffer_load_dwordx4 v7, s[20:23], s36 offen offset:2048 sc1 lds
    s_add_u32 s36, s36, 195072
    s_waitcnt vmcnt(11)
    s_cmp_lg_u32 s26, 4
    s_cbranch_scc1 L_o4c1
    v_cmp_ne_u64 vcc, s[92:93], v[24:25]
    v_cmp_ne_u64 s[88:89], s[92:93], v[26:27]
    s_or_b64 vcc, vcc, s[88:89]
    v_cmp_ne_u64 s[88:89], s[92:93], v[28:29]
    s_or_b64 vcc, vcc, s[88:89]
    v_cmp_ne_u64 s[88:89], s[92:93], v[30:31]
    s_or_b64 vcc, vcc, s[88:89]
    s_cbranch_scc0 L_o4c1
    s_mov_b32 s31, 0
L_poll1:
    s_mov_b32 s30, 30324992
    buffer_load_dwordx4 v[24:27], v36, s[20:23], s30 offen sc1
    buffer_load_dwordx4 v[28:31], v36, s[20:23], s30 offen offset:16 sc1
    s_add_u32 s31, s31, 1
    s_cmp_gt_u32 s31, 400000
    s_cbranch_scc1 L_pdone1
    s_waitcnt vmcnt(0)
    v_cmp_ne_u64 vcc, s[92:93], v[24:25]
    v_cmp_ne_u64 s[88:89], s[92:93], v[26:27]
    s_or_b64 vcc, vcc, s[88:89]
    v_cmp_ne_u64 s[88:89], s[92:93], v[28:29]
    s_or_b64 vcc, vcc, s[88:89]
    v_cmp_ne_u64 s[88:89], s[92:93], v[30:31]
    s_or_b64 vcc, vcc, s[88:89]
    s_cbranch_scc0 L_pdone1
    s_mov_b64 exec, vcc
    s_sleep 6
    s_branch L_poll1
L_pdone1:
    s_mov_b64 exec, -1
L_o4c1:
    s_barrier
    s_lshl_b32 s30, s2, 3
    s_add_u32 s30, s30, 30329344
    s_mov_b64 exec, 1
    buffer_store_dwordx2 v[38:39], v12, s[20:23], s30 offen sc1
    s_mov_b64 exec, -1
    s_add_u32 m0, s35, 135168
    s_nop 0
    buffer_load_dwordx4 v3, s[20:23], s37 offen offset:0 sc1 lds
    v_mul_f32 v40, s40, v148
    v_mul_f32 v41, s40, v149
    s_add_u32 m0, s35, 135168
    s_nop 0
    buffer_load_dwordx4 v3, s[20:23], s37 offen offset:1024 sc1 lds
    v_mul_f32 v42, s40, v150
    v_mul_f32 v43, s40, v151
    s_add_u32 m0, s35, 135168
    s_nop 0
    buffer_load_dwordx4 v3, s[20:23], s37 offen offset:2048 sc1 lds
    v_mul_f32 v112, s42, v148
    v_mul_f32 v113, s42, v149
    s_add_u32 m0, s35, 135168
    s_nop 0
    buffer_load_dwordx4 v3, s[20:23], s37 offen offset:3072 sc1 lds
    v_mul_f32 v114, s42, v150
    v_mul_f32 v115, s42, v151
    s_add_u32 m0, s35, 139264
    s_nop 0
    buffer_load_dwordx4 v13, s[20:23], s37 offen offset:0 sc1 lds
    v_mul_f32 v44, s40, v152
    v_mul_f32 v45, s40, v153
    s_add_u32 m0, s35, 139264
    s_nop 0
    buffer_load_dwordx4 v13, s[20:23], s37 offen offset:1024 sc1 lds
    s_add_u32 s37, s37, 24576
    v_mul_f32 v46, s40, v154
    v_mul_f32 v47, s40, v155
    s_add_u32 m0, s34, 0
    s_nop 0
    buffer_load_dwordx4 v3, s[20:23], s36 offen offset:0 sc1 lds
    v_mul_f32 v116, s42, v152
    v_mul_f32 v117, s42, v153
    s_add_u32 m0, s34, 0
    s_nop 0
    buffer_load_dwordx4 v3, s[20:23], s36 offen offset:1024 sc1 lds
    v_mul_f32 v118, s42, v154
    v_mul_f32 v119, s42, v155
    s_add_u32 m0, s34, 0
    s_nop 0
    buffer_load_dwordx4 v3, s[20:23], s36 offen offset:2048 sc1 lds
    v_mul_f32 v48, s40, v156
    v_mul_f32 v49, s40, v157
    s_add_u32 m0, s34, 0
    s_nop 0
    buffer_load_dwordx4 v3, s[20:23], s36 offen offset:3072 sc1 lds
    v_mul_f32 v50, s40, v158
    v_mul_f32 v51, s40, v159
    v_mul_f32 v120, s42, v156
    s_add_u32 m0, s34, 4096
    s_nop 0
    buffer_load_dwordx4 v13, s[20:23], s36 offen offset:0 sc1 lds
    v_mul_f32 v121, s42, v157
    v_mul_f32 v122, s42, v158
    s_add_u32 m0, s34, 4096
    s_nop 0
    buffer_load_dwordx4 v6, s[20:23], s36 offen offset:1024 sc1 lds
    v_mul_f32 v123, s42, v159
    v_mul_f32 v52, s40, v160
    s_add_u32 m0, s34, 4096
    s_nop 0
    buffer_load_dwordx4 v7, s[20:23], s36 offen offset:2048 sc1 lds
    s_add_u32 s36, s36, 195072
    v_mul_f32 v53, s40, v161
    v_mul_f32 v54, s40, v162
    s_add_u32 m0, s35, 28672
    s_nop 0
    buffer_load_dwordx4 v3, s[20:23], s37 offen offset:0 sc1 lds
    v_mul_f32 v55, s40, v163
    v_mul_f32 v124, s42, v160
    s_add_u32 m0, s35, 28672
    s_nop 0
    buffer_load_dwordx4 v3, s[20:23], s37 offen offset:1024 sc1 lds
    v_mul_f32 v125, s42, v161
    v_mul_f32 v126, s42, v162
    s_add_u32 m0, s35, 28672
    s_nop 0
    buffer_load_dwordx4 v3, s[20:23], s37 offen offset:2048 sc1 lds
    v_mul_f32 v127, s42, v163
    v_mul_f32 v56, s40, v164
    s_add_u32 m0, s35, 28672
    s_nop 0
    buffer_load_dwordx4 v3, s[20:23], s37 offen offset:3072 sc1 lds
    v_mul_f32 v57, s40, v165
    v_mul_f32 v58, s40, v166
    s_add_u32 m0, s35, 32768
    s_nop 0
    buffer_load_dwordx4 v13, s[20:23], s37 offen offset:0 sc1 lds
    v_mul_f32 v59, s40, v167
    v_mul_f32 v128, s42, v164
    s_add_u32 m0, s35, 32768
    s_nop 0
    buffer_load_dwordx4 v13, s[20:23], s37 offen offset:1024 sc1 lds
    s_add_u32 s37, s37, 24576
    v_mul_f32 v129, s42, v165
    v_mul_f32 v130, s42, v166
    v_mul_f32 v131, s42, v167
    s_waitcnt vmcnt(13)
    s_barrier
    s_lshl_b32 s30, s2, 3
    s_add_u32 s30, s30, 30333696
    s_mov_b64 exec, 1
    buffer_store_dwordx2 v[38:39], v12, s[20:23], s30 offen sc1
    s_mov_b64 exec, -1
    buffer_store_dwordx4 v[232:235], v32, s[20:23], 0 offen sc1
    v_add_u32 v32, s96, v32
    v_mul_f32 v60, s40, v168
    buffer_store_dwordx4 v[236:239], v33, s[20:23], 0 offen sc1
    v_add_u32 v33, s97, v33
    v_mul_f32 v61, s40, v169
    v_mul_f32 v62, s40, v170
    buffer_store_dwordx4 v[240:243], v34, s[20:23], 0 offen sc1
    v_add_u32 v34, s98, v34
    v_mul_f32 v63, s40, v171
    v_mul_f32 v132, s42, v168
    buffer_store_dwordx4 v[244:247], v35, s[20:23], 0 offen sc1
    v_add_u32 v35, s99, v35
    v_mul_f32 v133, s42, v169
    v_mul_f32 v134, s42, v170
    s_add_u32 m0, s34, 53248
    s_nop 0
    buffer_load_dwordx4 v3, s[20:23], s36 offen offset:0 sc1 lds
    v_mul_f32 v135, s42, v171
    v_mul_f32 v64, s40, v172
    s_add_u32 m0, s34, 53248
    s_nop 0
    buffer_load_dwordx4 v3, s[20:23], s36 offen offset:1024 sc1 lds
    v_mul_f32 v65, s40, v173
    v_mul_f32 v66, s40, v174
    s_add_u32 m0, s34, 53248
    s_nop 0
    buffer_load_dwordx4 v3, s[20:23], s36 offen offset:2048 sc1 lds
    v_mul_f32 v67, s40, v175
    v_mul_f32 v136, s42, v172
    s_add_u32 m0, s34, 53248
    s_nop 0
    buffer_load_dwordx4 v3, s[20:23], s36 offen offset:3072 sc1 lds
    v_mul_f32 v137, s42, v173
    v_mul_f32 v138, s42, v174
    s_add_u32 m0, s34, 57344
    s_nop 0
    buffer_load_dwordx4 v13, s[20:23], s36 offen offset:0 sc1 lds
    v_mul_f32 v139, s42, v175
    s_add_u32 m0, s34, 57344
    s_nop 0
    buffer_load_dwordx4 v6, s[20:23], s36 offen offset:1024 sc1 lds
    v_mul_f32 v68, s40, v176
    v_mul_f32 v69, s40, v177
    s_add_u32 m0, s34, 57344
    s_nop 0
    buffer_load_dwordx4 v7, s[20:23], s36 offen offset:2048 sc1 lds
    s_add_u32 s36, s36, 195072
    v_mul_f32 v70, s40, v178
    v_mul_f32 v71, s40, v179
    s_add_u32 m0, s35, 81920
    s_nop 0
    buffer_load_dwordx4 v3, s[20:23], s37 offen offset:0 sc1 lds
    v_mul_f32 v140, s42, v176
    v_mul_f32 v141, s42, v177
    s_add_u32 m0, s35, 81920
    s_nop 0
    buffer_load_dwordx4 v3, s[20:23], s37 offen offset:1024 sc1 lds
    v_mul_f32 v142, s42, v178
    v_mul_f32 v143, s42, v179
    s_add_u32 m0, s35, 81920
    s_nop 0
    buffer_load_dwordx4 v3, s[20:23], s37 offen offset:2048 sc1 lds
    v_mul_f32 v72, s40, v180
    v_mul_f32 v73, s40, v181
    s_add_u32 m0, s35, 81920
    s_nop 0
    buffer_load_dwordx4 v3, s[20:23], s37 offen offset:3072 sc1 lds
    v_mul_f32 v74, s40, v182
    v_mul_f32 v75, s40, v183
    s_add_u32 m0, s35, 86016
    s_nop 0
    buffer_load_dwordx4 v13, s[20:23], s37 offen offset:0 sc1 lds
    v_mul_f32 v144, s42, v180
    v_mul_f32 v145, s42, v181
    s_add_u32 m0, s35, 86016
    s_nop 0
    buffer_load_dwordx4 v13, s[20:23], s37 offen offset:1024 sc1 lds
    s_add_u32 s37, s37, 24576
    v_mul_f32 v146, s42, v182
    v_mul_f32 v147, s42, v183
    s_mov_b32 s40, s43
    s_mov_b32 s41, s44
    s_mov_b32 s42, s45
    s_mov_b32 s43, s46
    s_mov_b32 s44, s47
    s_mov_b32 s45, s48
    s_mov_b32 s46, s49
    s_mov_b32 s47, s50
    s_mov_b32 s48, s51
    s_mov_b32 s49, s52
    s_mov_b32 s50, s53
    s_mov_b32 s51, s54
    s_mov_b32 s52, s55
    s_mov_b32 s53, s56
    s_mov_b32 s54, s57
    s_waitcnt vmcnt(18)
    s_barrier
    s_mov_b32 s30, 30329344
    buffer_load_dwordx4 v[24:27], v36, s[20:23], s30 offen sc1
    buffer_load_dwordx4 v[28:31], v36, s[20:23], s30 offen offset:16 sc1
    buffer_store_dwordx4 v[248:251], v32, s[20:23], 0 offen sc1
    v_add_u32 v32, s96, v32
    buffer_store_dwordx4 v[252:255], v33, s[20:23], 0 offen sc1
    v_add_u32 v33, s97, v33
    buffer_store_dwordx4 v[16:19], v34, s[20:23], 0 offen sc1
    v_add_u32 v34, s98, v34
    buffer_store_dwordx4 v[20:23], v35, s[20:23], 0 offen sc1
    v_add_u32 v35, s99, v35
    s_barrier
    ds_read_b128 v[148:151], v4 offset:0
    ds_read_b128 v[152:155], v4 offset:1024
    ds_read_b128 v[156:159], v4 offset:2048
    ds_read_b128 v[160:163], v4 offset:3072
    ds_read_b128 v[164:167], v4 offset:4096
    ds_read_b128 v[168:171], v4 offset:5120
    ds_read_b128 v[172:175], v4 offset:6144
    ds_read_b128 v[176:179], v5 offset:0
    ds_read_b128 v[180:183], v5 offset:1024
    s_waitcnt lgkmcnt(0)
    s_add_u32 m0, s34, 106496
    s_nop 0
    buffer_load_dwordx4 v3, s[20:23], s36 offen offset:0 sc1 lds
    s_add_u32 m0, s34, 106496
    s_nop 0
    buffer_load_dwordx4 v3, s[20:23], s36 offen offset:1024 sc1 lds
    s_add_u32 m0, s34, 106496
    s_nop 0
    buffer_load_dwordx4 v3, s[20:23], s36 offen offset:2048 sc1 lds
    s_add_u32 m0, s34, 106496
    s_nop 0
    buffer_load_dwordx4 v3, s[20:23], s36 offen offset:3072 sc1 lds
    s_add_u32 m0, s34, 110592
    s_nop 0
    buffer_load_dwordx4 v13, s[20:23], s36 offen offset:0 sc1 lds
    s_add_u32 m0, s34, 110592
    s_nop 0
    buffer_load_dwordx4 v6, s[20:23], s36 offen offset:1024 sc1 lds
    s_add_u32 m0, s34, 110592
    s_nop 0
    buffer_load_dwordx4 v7, s[20:23], s36 offen offset:2048 sc1 lds
    s_add_u32 s36, s36, 195072
    s_waitcnt vmcnt(11)
    s_cmp_lg_u32 s26, 4
    s_cbranch_scc1 L_o4c2
    v_cmp_ne_u64 vcc, s[92:93], v[24:25]
    v_cmp_ne_u64 s[88:89], s[92:93], v[26:27]
    s_or_b64 vcc, vcc, s[88:89]
    v_cmp_ne_u64 s[88:89], s[92:93], v[28:29]
    s_or_b64 vcc, vcc, s[88:89]
    v_cmp_ne_u64 s[88:89], s[92:93], v[30:31]
    s_or_b64 vcc, vcc, s[88:89]
    s_cbranch_scc0 L_o4c2
    s_mov_b32 s31, 0
L_poll2:
    s_mov_b32 s30, 30329344
    buffer_load_dwordx4 v[24:27], v36, s[20:23], s30 offen sc1
    buffer_load_dwordx4 v[28:31], v36, s[20:23], s30 offen offset:16 sc1
    s_add_u32 s31, s31, 1
    s_cmp_gt_u32 s31, 400000
    s_cbranch_scc1 L_pdone2
    s_waitcnt vmcnt(0)
    v_cmp_ne_u64 vcc, s[92:93], v[24:25]
    v_cmp_ne_u64 s[88:89], s[92:93], v[26:27]
    s_or_b64 vcc, vcc, s[88:89]
    v_cmp_ne_u64 s[88:89], s[92:93], v[28:29]
    s_or_b64 vcc, vcc, s[88:89]
    v_cmp_ne_u64 s[88:89], s[92:93], v[30:31]
    s_or_b64 vcc, vcc, s[88:89]
    s_cbranch_scc0 L_pdone2
    s_mov_b64 exec, vcc
    s_sleep 6
    s_branch L_poll2
L_pdone2:
    s_mov_b64 exec, -1
L_o4c2:
    s_barrier
    s_add_u32 m0, s35, 135168
    s_nop 0
    buffer_load_dwordx4 v3, s[20:23], s37 offen offset:0 sc1 lds
    v_fmac_f32 v40, s40, v148
    v_fmac_f32 v41, s40, v149
    s_add_u32 m0, s35, 135168
    s_nop 0
    buffer_load_dwordx4 v3, s[20:23], s37 offen offset:1024 sc1 lds
    v_fmac_f32 v42, s40, v150
    v_fmac_f32 v43, s40, v151
    s_add_u32 m0, s35, 135168
    s_nop 0
    buffer_load_dwordx4 v3, s[20:23], s37 offen offset:2048 sc1 lds
    v_mul_f32 v76, s41, v148
    v_mul_f32 v77, s41, v149
    s_add_u32 m0, s35, 135168
    s_nop 0
    buffer_load_dwordx4 v3, s[20:23], s37 offen offset:3072 sc1 lds
    v_mul_f32 v78, s41, v150
    v_mul_f32 v79, s41, v151
    s_add_u32 m0, s35, 139264
    s_nop 0
    buffer_load_dwordx4 v13, s[20:23], s37 offen offset:0 sc1 lds
    v_fmac_f32 v112, s42, v148
    v_fmac_f32 v113, s42, v149
    s_add_u32 m0, s35, 139264
    s_nop 0
    buffer_load_dwordx4 v13, s[20:23], s37 offen offset:1024 sc1 lds
    s_add_u32 s37, s37, 24576
    v_fmac_f32 v114, s42, v150
    v_fmac_f32 v115, s42, v151
    s_add_u32 m0, s34, 0
    s_nop 0
    buffer_load_dwordx4 v3, s[20:23], s36 offen offset:0 sc1 lds
    v_fmac_f32 v44, s40, v152
    v_fmac_f32 v45, s40, v153
    s_add_u32 m0, s34, 0
    s_nop 0
    buffer_load_dwordx4 v3, s[20:23], s36 offen offset:1024 sc1 lds
    v_fmac_f32 v46, s40, v154
    v_fmac_f32 v47, s40, v155
    s_add_u32 m0, s34, 0
    s_nop 0
    buffer_load_dwordx4 v3, s[20:23], s36 offen offset:2048 sc1 lds
    v_mul_f32 v80, s41, v152
    v_mul_f32 v81, s41, v153
    s_add_u32 m0, s34, 0
    s_nop 0
    buffer_load_dwordx4 v3, s[20:23], s36 offen offset:3072 sc1 lds
    v_mul_f32 v82, s41, v154
    v_mul_f32 v83, s41, v155
    v_fmac_f32 v116, s42, v152
    s_add_u32 m0, s34, 4096
    s_nop 0
    buffer_load_dwordx4 v13, s[20:23], s36 offen offset:0 sc1 lds
    v_fmac_f32 v117, s42, v153
    v_fmac_f32 v118, s42, v154
    s_add_u32 m0, s34, 4096
    s_nop 0
    buffer_load_dwordx4 v6, s[20:23], s36 offen offset:1024 sc1 lds
    v_fmac_f32 v119, s42, v155
    v_fmac_f32 v48, s40, v156
    s_add_u32 m0, s34, 4096
    s_nop 0
    buffer_load_dwordx4 v7, s[20:23], s36 offen offset:2048 sc1 lds
    s_add_u32 s36, s36, 195072
    v_fmac_f32 v49, s40, v157
    v_fmac_f32 v50, s40, v158
    s_add_u32 m0, s35, 28672
    s_nop 0
    buffer_load_dwordx4 v3, s[20:23], s37 offen offset:0 sc1 lds
    v_fmac_f32 v51, s40, v159
    v_mul_f32 v84, s41, v156
    s_add_u32 m0, s35, 28672
    s_nop 0
    buffer_load_dwordx4 v3, s[20:23], s37 offen offset:1024 sc1 lds
    v_mul_f32 v85, s41, v157
    v_mul_f32 v86, s41, v158
    s_add_u32 m0, s35, 28672
    s_nop 0
    buffer_load_dwordx4 v3, s[20:23], s37 offen offset:2048 sc1 lds
    v_mul_f32 v87, s41, v159
    v_fmac_f32 v120, s42, v156
    s_add_u32 m0, s35, 28672
    s_nop 0
    buffer_load_dwordx4 v3, s[20:23], s37 offen offset:3072 sc1 lds
    v_fmac_f32 v121, s42, v157
    v_fmac_f32 v122, s42, v158
    s_add_u32 m0, s35, 32768
    s_nop 0
    buffer_load_dwordx4 v13, s[20:23], s37 offen offset:0 sc1 lds
    v_fmac_f32 v123, s42, v159
    v_fmac_f32 v52, s40, v160
    s_add_u32 m0, s35, 32768
    s_nop 0
    buffer_load_dwordx4 v13, s[20:23], s37 offen offset:1024 sc1 lds
    s_add_u32 s37, s37, 24576
    v_fmac_f32 v53, s40, v161
    v_fmac_f32 v54, s40, v162
    v_fmac_f32 v55, s40, v163
    s_waitcnt vmcnt(13)
    s_barrier
    s_lshl_b32 s30, s2, 3
    s_add_u32 s30, s30, 30338048
    s_mov_b64 exec, 1
    buffer_store_dwordx2 v[38:39], v12, s[20:23], s30 offen sc1
    s_mov_b64 exec, -1
    s_add_u32 m0, s34, 53248
    s_nop 0
    buffer_load_dwordx4 v3, s[20:23], s36 offen offset:0 sc1 lds
    v_mul_f32 v88, s41, v160
    v_mul_f32 v89, s41, v161
    v_mul_f32 v90, s41, v162
    v_mul_f32 v91, s41, v163
    v_fmac_f32 v124, s42, v160
    s_add_u32 m0, s34, 53248
    s_nop 0
    buffer_load_dwordx4 v3, s[20:23], s36 offen offset:1024 sc1 lds
    v_fmac_f32 v125, s42, v161
    v_fmac_f32 v126, s42, v162
    v_fmac_f32 v127, s42, v163
    v_fmac_f32 v56, s40, v164
    v_fmac_f32 v57, s40, v165
    s_add_u32 m0, s34, 53248
    s_nop 0
    buffer_load_dwordx4 v3, s[20:23], s36 offen offset:2048 sc1 lds
    v_fmac_f32 v58, s40, v166
    v_fmac_f32 v59, s40, v167
    v_mul_f32 v92, s41, v164
    v_mul_f32 v93, s41, v165
    v_mul_f32 v94, s41, v166
    s_add_u32 m0, s34, 53248
    s_nop 0
    buffer_load_dwordx4 v3, s[20:23], s36 offen offset:3072 sc1 lds
    v_mul_f32 v95, s41, v167
    v_fmac_f32 v128, s42, v164
    v_fmac_f32 v129, s42, v165
    v_fmac_f32 v130, s42, v166
    v_fmac_f32 v131, s42, v167
    s_add_u32 m0, s34, 57344
    s_nop 0
    buffer_load_dwordx4 v13, s[20:23], s36 offen offset:0 sc1 lds
    v_fmac_f32 v60, s40, v168
    v_fmac_f32 v61, s40, v169
    v_fmac_f32 v62, s40, v170
    v_fmac_f32 v63, s40, v171
    v_mul_f32 v96, s41, v168
    v_mul_f32 v97, s41, v169
    s_add_u32 m0, s34, 57344
    s_nop 0
    buffer_load_dwordx4 v6, s[20:23], s36 offen offset:1024 sc1 lds
    v_mul_f32 v98, s41, v170
    v_mul_f32 v99, s41, v171
    v_fmac_f32 v132, s42, v168
    v_fmac_f32 v133, s42, v169
    v_fmac_f32 v134, s42, v170
    s_add_u32 m0, s34, 57344
    s_nop 0
    buffer_load_dwordx4 v7, s[20:23], s36 offen offset:2048 sc1 lds
    s_add_u32 s36, s36, 195072
    v_fmac_f32 v135, s42, v171
    v_fmac_f32 v64, s40, v172
    v_fmac_f32 v65, s40, v173
    v_fmac_f32 v66, s40, v174
    v_fmac_f32 v67, s40, v175
    s_add_u32 m0, s35, 81920
    s_nop 0
    buffer_load_dwordx4 v3, s[20:23], s37 offen offset:0 sc1 lds
    v_mul_f32 v100, s41, v172
    v_mul_f32 v101, s41, v173
    v_mul_f32 v102, s41, v174
    v_mul_f32 v103, s41, v175
    v_fmac_f32 v136, s42, v172
    s_add_u32 m0, s35, 81920
    s_nop 0
    buffer_load_dwordx4 v3, s[20:23], s37 offen offset:1024 sc1 lds
    v_fmac_f32 v137, s42, v173
    v_fmac_f32 v138, s42, v174
    v_fmac_f32 v139, s42, v175
    v_fmac_f32 v68, s40, v176
    v_fmac_f32 v69, s40, v177
    v_fmac_f32 v70, s40, v178
    s_add_u32 m0, s35, 81920
    s_nop 0
    buffer_load_dwordx4 v3, s[20:23], s37 offen offset:2048 sc1 lds
    v_fmac_f32 v71, s40, v179
    v_mul_f32 v104, s41, v176
    v_mul_f32 v105, s41, v177
    v_mul_f32 v106, s41, v178
    v_mul_f32 v107, s41, v179
    s_add_u32 m0, s35, 81920
    s_nop 0
    buffer_load_dwordx4 v3, s[20:23], s37 offen offset:3072 sc1 lds
    v_fmac_f32 v140, s42, v176
    v_fmac_f32 v141, s42, v177
    v_fmac_f32 v142, s42, v178
    v_fmac_f32 v143, s42, v179
    v_fmac_f32 v72, s40, v180
    s_add_u32 m0, s35, 86016
    s_nop 0
    buffer_load_dwordx4 v13, s[20:23], s37 offen offset:0 sc1 lds
    v_fmac_f32 v73, s40, v181
    v_fmac_f32 v74, s40, v182
    v_fmac_f32 v75, s40, v183
    v_mul_f32 v108, s41, v180
    v_mul_f32 v109, s41, v181
    s_add_u32 m0, s35, 86016
    s_nop 0
    buffer_load_dwordx4 v13, s[20:23], s37 offen offset:1024 sc1 lds
    s_add_u32 s37, s37, 24576
    v_mul_f32 v110, s41, v182
    v_mul_f32 v111, s41, v183
    v_fmac_f32 v144, s42, v180
    v_fmac_f32 v145, s42, v181
    v_fmac_f32 v146, s42, v182
    v_fmac_f32 v147, s42, v183
    s_mov_b32 s40, s43
    s_mov_b32 s41, s44
    s_mov_b32 s42, s45
    s_mov_b32 s43, s46
    s_mov_b32 s44, s47
    s_mov_b32 s45, s48
    s_mov_b32 s46, s49
    s_mov_b32 s47, s50
    s_mov_b32 s48, s51
    s_mov_b32 s49, s52
    s_mov_b32 s50, s53
    s_mov_b32 s51, s54
    s_mov_b32 s52, s55
    s_mov_b32 s53, s56
    s_mov_b32 s54, s57
    s_waitcnt vmcnt(14)
    s_barrier
    s_mov_b32 s30, 30333696
    buffer_load_dwordx4 v[24:27], v36, s[20:23], s30 offen sc1
    buffer_load_dwordx4 v[28:31], v36, s[20:23], s30 offen offset:16 sc1
    s_barrier
    ds_read_b128 v[148:151], v4 offset:0
    ds_read_b128 v[152:155], v4 offset:1024
    ds_read_b128 v[156:159], v4 offset:2048
    ds_read_b128 v[160:163], v4 offset:3072
    ds_read_b128 v[164:167], v4 offset:4096
    ds_read_b128 v[168:171], v4 offset:5120
    ds_read_b128 v[172:175], v4 offset:6144
    ds_read_b128 v[176:179], v5 offset:0
    ds_read_b128 v[180:183], v5 offset:1024
    s_waitcnt lgkmcnt(0)
    s_add_u32 m0, s34, 106496
    s_nop 0
    buffer_load_dwordx4 v3, s[20:23], s36 offen offset:0 sc1 lds
    s_add_u32 m0, s34, 106496
    s_nop 0
    buffer_load_dwordx4 v3, s[20:23], s36 offen offset:1024 sc1 lds
    s_add_u32 m0, s34, 106496
    s_nop 0
    buffer_load_dwordx4 v3, s[20:23], s36 offen offset:2048 sc1 lds
    s_add_u32 m0, s34, 106496
    s_nop 0
    buffer_load_dwordx4 v3, s[20:23], s36 offen offset:3072 sc1 lds
    s_add_u32 m0, s34, 110592
    s_nop 0
    buffer_load_dwordx4 v13, s[20:23], s36 offen offset:0 sc1 lds
    s_add_u32 m0, s34, 110592
    s_nop 0
    buffer_load_dwordx4 v6, s[20:23], s36 offen offset:1024 sc1 lds
    s_add_u32 m0, s34, 110592
    s_nop 0
    buffer_load_dwordx4 v7, s[20:23], s36 offen offset:2048 sc1 lds
    s_add_u32 s36, s36, 195072
    s_waitcnt vmcnt(7)
    s_cmp_lg_u32 s26, 4
    s_cbranch_scc1 L_o4c3
    v_cmp_ne_u64 vcc, s[92:93], v[24:25]
    v_cmp_ne_u64 s[88:89], s[92:93], v[26:27]
    s_or_b64 vcc, vcc, s[88:89]
    v_cmp_ne_u64 s[88:89], s[92:93], v[28:29]
    s_or_b64 vcc, vcc, s[88:89]
    v_cmp_ne_u64 s[88:89], s[92:93], v[30:31]
    s_or_b64 vcc, vcc, s[88:89]
    s_cbranch_scc0 L_o4c3
    s_mov_b32 s31, 0
L_poll3:
    s_mov_b32 s30, 30333696
    buffer_load_dwordx4 v[24:27], v36, s[20:23], s30 offen sc1
    buffer_load_dwordx4 v[28:31], v36, s[20:23], s30 offen offset:16 sc1
    s_add_u32 s31, s31, 1
    s_cmp_gt_u32 s31, 400000
    s_cbranch_scc1 L_pdone3
    s_waitcnt vmcnt(0)
    v_cmp_ne_u64 vcc, s[92:93], v[24:25]
    v_cmp_ne_u64 s[88:89], s[92:93], v[26:27]
    s_or_b64 vcc, vcc, s[88:89]
    v_cmp_ne_u64 s[88:89], s[92:93], v[28:29]
    s_or_b64 vcc, vcc, s[88:89]
    v_cmp_ne_u64 s[88:89], s[92:93], v[30:31]
    s_or_b64 vcc, vcc, s[88:89]
    s_cbranch_scc0 L_pdone3
    s_mov_b64 exec, vcc
    s_sleep 6
    s_branch L_poll3
L_pdone3:
    s_mov_b64 exec, -1
L_o4c3:
    s_barrier
    s_add_u32 m0, s35, 135168
    s_nop 0
    buffer_load_dwordx4 v3, s[20:23], s37 offen offset:0 sc1 lds
    v_fmac_f32 v40, s40, v148
    v_fmac_f32 v41, s40, v149
    s_add_u32 m0, s35, 135168
    s_nop 0
    buffer_load_dwordx4 v3, s[20:23], s37 offen offset:1024 sc1 lds
    v_fmac_f32 v42, s40, v150
    v_fmac_f32 v43, s40, v151
    s_add_u32 m0, s35, 135168
    s_nop 0
    buffer_load_dwordx4 v3, s[20:23], s37 offen offset:2048 sc1 lds
    v_fmac_f32 v112, s42, v148
    v_fmac_f32 v113, s42, v149
    s_add_u32 m0, s35, 135168
    s_nop 0
    buffer_load_dwordx4 v3, s[20:23], s37 offen offset:3072 sc1 lds
    v_fmac_f32 v114, s42, v150
    v_fmac_f32 v115, s42, v151
    s_add_u32 m0, s35, 139264
    s_nop 0
    buffer_load_dwordx4 v13, s[20:23], s37 offen offset:0 sc1 lds
    v_fmac_f32 v44, s40, v152
    v_fmac_f32 v45, s40, v153
    s_add_u32 m0, s35, 139264
    s_nop 0
    buffer_load_dwordx4 v13, s[20:23], s37 offen offset:1024 sc1 lds
    s_add_u32 s37, s37, 24576
    v_fmac_f32 v46, s40, v154
    v_fmac_f32 v47, s40, v155
    s_add_u32 m0, s34, 0
    s_nop 0
    buffer_load_dwordx4 v3, s[20:23], s36 offen offset:0 sc1 lds
    v_fmac_f32 v116, s42, v152
    v_fmac_f32 v117, s42, v153
    s_add_u32 m0, s34, 0
    s_nop 0
    buffer_load_dwordx4 v3, s[20:23], s36 offen offset:1024 sc1 lds
    v_fmac_f32 v118, s42, v154
    v_fmac_f32 v119, s42, v155
    s_add_u32 m0, s34, 0
    s_nop 0
    buffer_load_dwordx4 v3, s[20:23], s36 offen offset:2048 sc1 lds
    v_fmac_f32 v48, s40, v156
    v_fmac_f32 v49, s40, v157
    s_add_u32 m0, s34, 0
    s_nop 0
    buffer_load_dwordx4 v3, s[20:23], s36 offen offset:3072 sc1 lds
    v_fmac_f32 v50, s40, v158
    v_fmac_f32 v51, s40, v159
    v_fmac_f32 v120, s42, v156
    s_add_u32 m0, s34, 4096
    s_nop 0
    buffer_load_dwordx4 v13, s[20:23], s36 offen offset:0 sc1 lds
    v_fmac_f32 v121, s42, v157
    v_fmac_f32 v122, s42, v158
    s_add_u32 m0, s34, 4096
    s_nop 0
    buffer_load_dwordx4 v6, s[20:23], s36 offen offset:1024 sc1 lds
    v_fmac_f32 v123, s42, v159
    v_fmac_f32 v52, s40, v160
    s_add_u32 m0, s34, 4096
    s_nop 0
    buffer_load_dwordx4 v7, s[20:23], s36 offen offset:2048 sc1 lds
    s_add_u32 s36, s36, 195072
    v_fmac_f32 v53, s40, v161
    v_fmac_f32 v54, s40, v162
    s_add_u32 m0, s35, 28672
    s_nop 0
    buffer_load_dwordx4 v3, s[20:23], s37 offen offset:0 sc1 lds
    v_fmac_f32 v55, s40, v163
    v_fmac_f32 v124, s42, v160
    s_add_u32 m0, s35, 28672
    s_nop 0
    buffer_load_dwordx4 v3, s[20:23], s37 offen offset:1024 sc1 lds
    v_fmac_f32 v125, s42, v161
    v_fmac_f32 v126, s42, v162
    s_add_u32 m0, s35, 28672
    s_nop 0
    buffer_load_dwordx4 v3, s[20:23], s37 offen offset:2048 sc1 lds
    v_fmac_f32 v127, s42, v163
    v_fmac_f32 v56, s40, v164
    s_add_u32 m0, s35, 28672
    s_nop 0
    buffer_load_dwordx4 v3, s[20:23], s37 offen offset:3072 sc1 lds
    v_fmac_f32 v57, s40, v165
    v_fmac_f32 v58, s40, v166
    s_add_u32 m0, s35, 32768
    s_nop 0
    buffer_load_dwordx4 v13, s[20:23], s37 offen offset:0 sc1 lds
    v_fmac_f32 v59, s40, v167
    v_fmac_f32 v128, s42, v164
    s_add_u32 m0, s35, 32768
    s_nop 0
    buffer_load_dwordx4 v13, s[20:23], s37 offen offset:1024 sc1 lds
    s_add_u32 s37, s37, 24576
    v_fmac_f32 v129, s42, v165
    v_fmac_f32 v130, s42, v166
    v_fmac_f32 v131, s42, v167
    s_waitcnt vmcnt(13)
    s_barrier
    s_add_u32 m0, s34, 53248
    s_nop 0
    buffer_load_dwordx4 v3, s[20:23], s36 offen offset:0 sc1 lds
    v_fmac_f32 v60, s40, v168
    v_fmac_f32 v61, s40, v169
    s_add_u32 m0, s34, 53248
    s_nop 0
    buffer_load_dwordx4 v3, s[20:23], s36 offen offset:1024 sc1 lds
    v_fmac_f32 v62, s40, v170
    v_fmac_f32 v63, s40, v171
    s_add_u32 m0, s34, 53248
    s_nop 0
    buffer_load_dwordx4 v3, s[20:23], s36 offen offset:2048 sc1 lds
    v_fmac_f32 v132, s42, v168
    v_fmac_f32 v133, s42, v169
    v_fmac_f32 v134, s42, v170
    s_add_u32 m0, s34, 53248
    s_nop 0
    buffer_load_dwordx4 v3, s[20:23], s36 offen offset:3072 sc1 lds
    v_fmac_f32 v135, s42, v171
    v_fmac_f32 v64, s40, v172
    s_add_u32 m0, s34, 57344
    s_nop 0
    buffer_load_dwordx4 v13, s[20:23], s36 offen offset:0 sc1 lds
    v_fmac_f32 v65, s40, v173
    v_fmac_f32 v66, s40, v174
    v_fmac_f32 v67, s40, v175
    s_add_u32 m0, s34, 57344
    s_nop 0
    buffer_load_dwordx4 v6, s[20:23], s36 offen offset:1024 sc1 lds
    v_fmac_f32 v136, s42, v172
    v_fmac_f32 v137, s42, v173
    s_add_u32 m0, s34, 57344
    s_nop 0
    buffer_load_dwordx4 v7, s[20:23], s36 offen offset:2048 sc1 lds
    s_add_u32 s36, s36, 195072
    v_fmac_f32 v138, s42, v174
    v_fmac_f32 v139, s42, v175
    v_fmac_f32 v68, s40, v176
    s_add_u32 m0, s35, 81920
    s_nop 0
    buffer_load_dwordx4 v3, s[20:23], s37 offen offset:0 sc1 lds
    v_fmac_f32 v69, s40, v177
    v_fmac_f32 v70, s40, v178
    s_add_u32 m0, s35, 81920
    s_nop 0
    buffer_load_dwordx4 v3, s[20:23], s37 offen offset:1024 sc1 lds
    v_fmac_f32 v71, s40, v179
    v_fmac_f32 v140, s42, v176
    v_fmac_f32 v141, s42, v177
    s_add_u32 m0, s35, 81920
    s_nop 0
    buffer_load_dwordx4 v3, s[20:23], s37 offen offset:2048 sc1 lds
    v_fmac_f32 v142, s42, v178
    v_fmac_f32 v143, s42, v179
    s_add_u32 m0, s35, 81920
    s_nop 0
    buffer_load_dwordx4 v3, s[20:23], s37 offen offset:3072 sc1 lds
    v_fmac_f32 v72, s40, v180
    v_fmac_f32 v73, s40, v181
    v_fmac_f32 v74, s40, v182
    s_add_u32 m0, s35, 86016
    s_nop 0
    buffer_load_dwordx4 v13, s[20:23], s37 offen offset:0 sc1 lds
    v_fmac_f32 v75, s40, v183
    v_fmac_f32 v144, s42, v180
    s_add_u32 m0, s35, 86016
    s_nop 0
    buffer_load_dwordx4 v13, s[20:23], s37 offen offset:1024 sc1 lds
    s_add_u32 s37, s37, 24576
    v_fmac_f32 v145, s42, v181
    v_fmac_f32 v146, s42, v182
    v_fmac_f32 v147, s42, v183
    s_mov_b32 s40, s43
    s_mov_b32 s41, s44
    s_mov_b32 s42, s45
    s_mov_b32 s43, s46
    s_mov_b32 s44, s47
    s_mov_b32 s45, s48
    s_mov_b32 s46, s49
    s_mov_b32 s47, s50
    s_mov_b32 s48, s51
    s_mov_b32 s49, s52
    s_mov_b32 s50, s53
    s_mov_b32 s51, s54
    s_mov_b32 s52, s55
    s_mov_b32 s53, s56
    s_mov_b32 s54, s57
    s_waitcnt vmcnt(13)
    s_barrier
    s_mov_b32 s30, 30338048
    buffer_load_dwordx4 v[24:27], v36, s[20:23], s30 offen sc1
    buffer_load_dwordx4 v[28:31], v36, s[20:23], s30 offen offset:16 sc1
    s_barrier
    ds_read_b128 v[148:151], v4 offset:0
    ds_read_b128 v[152:155], v4 offset:1024
    ds_read_b128 v[156:159], v4 offset:2048
    ds_read_b128 v[160:163], v4 offset:3072
    ds_read_b128 v[164:167], v4 offset:4096
    ds_read_b128 v[168:171], v4 offset:5120
    ds_read_b128 v[172:175], v4 offset:6144
    ds_read_b128 v[176:179], v5 offset:0
    ds_read_b128 v[180:183], v5 offset:1024
    s_waitcnt lgkmcnt(0)
    s_add_u32 m0, s34, 106496
    s_nop 0
    buffer_load_dwordx4 v3, s[20:23], s36 offen offset:0 sc1 lds
    s_add_u32 m0, s34, 106496
    s_nop 0
    buffer_load_dwordx4 v3, s[20:23], s36 offen offset:1024 sc1 lds
    s_add_u32 m0, s34, 106496
    s_nop 0
    buffer_load_dwordx4 v3, s[20:23], s36 offen offset:2048 sc1 lds
    s_add_u32 m0, s34, 106496
    s_nop 0
    buffer_load_dwordx4 v3, s[20:23], s36 offen offset:3072 sc1 lds
    s_add_u32 m0, s34, 110592
    s_nop 0
    buffer_load_dwordx4 v13, s[20:23], s36 offen offset:0 sc1 lds
    s_add_u32 m0, s34, 110592
    s_nop 0
    buffer_load_dwordx4 v6, s[20:23], s36 offen offset:1024 sc1 lds
    s_add_u32 m0, s34, 110592
    s_nop 0
    buffer_load_dwordx4 v7, s[20:23], s36 offen offset:2048 sc1 lds
    s_add_u32 s36, s36, 195072
    s_waitcnt vmcnt(7)
    s_cmp_lg_u32 s26, 4
    s_cbranch_scc1 L_o4c4
    v_cmp_ne_u64 vcc, s[92:93], v[24:25]
    v_cmp_ne_u64 s[88:89], s[92:93], v[26:27]
    s_or_b64 vcc, vcc, s[88:89]
    v_cmp_ne_u64 s[88:89], s[92:93], v[28:29]
    s_or_b64 vcc, vcc, s[88:89]
    v_cmp_ne_u64 s[88:89], s[92:93], v[30:31]
    s_or_b64 vcc, vcc, s[88:89]
    s_cbranch_scc0 L_o4c4
    s_mov_b32 s31, 0
L_poll4:
    s_mov_b32 s30, 30338048
    buffer_load_dwordx4 v[24:27], v36, s[20:23], s30 offen sc1
    buffer_load_dwordx4 v[28:31], v36, s[20:23], s30 offen offset:16 sc1
    s_add_u32 s31, s31, 1
    s_cmp_gt_u32 s31, 400000
    s_cbranch_scc1 L_pdone4
    s_waitcnt vmcnt(0)
    v_cmp_ne_u64 vcc, s[92:93], v[24:25]
    v_cmp_ne_u64 s[88:89], s[92:93], v[26:27]
    s_or_b64 vcc, vcc, s[88:89]
    v_cmp_ne_u64 s[88:89], s[92:93], v[28:29]
    s_or_b64 vcc, vcc, s[88:89]
    v_cmp_ne_u64 s[88:89], s[92:93], v[30:31]
    s_or_b64 vcc, vcc, s[88:89]
    s_cbranch_scc0 L_pdone4
    s_mov_b64 exec, vcc
    s_sleep 6
    s_branch L_poll4
L_pdone4:
    s_mov_b64 exec, -1
L_o4c4:
    s_barrier
    s_add_u32 m0, s35, 135168
    s_nop 0
    buffer_load_dwordx4 v3, s[20:23], s37 offen offset:0 sc1 lds
    v_fmac_f32 v40, s40, v148
    v_fmac_f32 v41, s40, v149
    s_add_u32 m0, s35, 135168
    s_nop 0
    buffer_load_dwordx4 v3, s[20:23], s37 offen offset:1024 sc1 lds
    v_fmac_f32 v42, s40, v150
    v_fmac_f32 v43, s40, v151
    s_add_u32 m0, s35, 135168
    s_nop 0
    buffer_load_dwordx4 v3, s[20:23], s37 offen offset:2048 sc1 lds
    v_fmac_f32 v76, s41, v148
    v_fmac_f32 v77, s41, v149
    s_add_u32 m0, s35, 135168
    s_nop 0
    buffer_load_dwordx4 v3, s[20:23], s37 offen offset:3072 sc1 lds
    v_fmac_f32 v78, s41, v150
    v_fmac_f32 v79, s41, v151
    s_add_u32 m0, s35, 139264
    s_nop 0
    buffer_load_dwordx4 v13, s[20:23], s37 offen offset:0 sc1 lds
    v_fmac_f32 v112, s42, v148
    v_fmac_f32 v113, s42, v149
    s_add_u32 m0, s35, 139264
    s_nop 0
    buffer_load_dwordx4 v13, s[20:23], s37 offen offset:1024 sc1 lds
    s_add_u32 s37, s37, 24576
    v_fmac_f32 v114, s42, v150
    v_fmac_f32 v115, s42, v151
    s_add_u32 m0, s34, 0
    s_nop 0
    buffer_load_dwordx4 v3, s[20:23], s36 offen offset:0 sc1 lds
    v_fmac_f32 v44, s40, v152
    v_fmac_f32 v45, s40, v153
    s_add_u32 m0, s34, 0
    s_nop 0
    buffer_load_dwordx4 v3, s[20:23], s36 offen offset:1024 sc1 lds
    v_fmac_f32 v46, s40, v154
    v_fmac_f32 v47, s40, v155
    s_add_u32 m0, s34, 0
    s_nop 0
    buffer_load_dwordx4 v3, s[20:23], s36 offen offset:2048 sc1 lds
    v_fmac_f32 v80, s41, v152
    v_fmac_f32 v81, s41, v153
    s_add_u32 m0, s34, 0
    s_nop 0
    buffer_load_dwordx4 v3, s[20:23], s36 offen offset:3072 sc1 lds
    v_fmac_f32 v82, s41, v154
    v_fmac_f32 v83, s41, v155
    v_fmac_f32 v116, s42, v152
    s_add_u32 m0, s34, 4096
    s_nop 0
    buffer_load_dwordx4 v13, s[20:23], s36 offen offset:0 sc1 lds
    v_fmac_f32 v117, s42, v153
    v_fmac_f32 v118, s42, v154
    s_add_u32 m0, s34, 4096
    s_nop 0
    buffer_load_dwordx4 v6, s[20:23], s36 offen offset:1024 sc1 lds
    v_fmac_f32 v119, s42, v155
    v_fmac_f32 v48, s40, v156
    s_add_u32 m0, s34, 4096
    s_nop 0
    buffer_load_dwordx4 v7, s[20:23], s36 offen offset:2048 sc1 lds
    s_add_u32 s36, s36, 195072
    v_fmac_f32 v49, s40, v157
    v_fmac_f32 v50, s40, v158
    s_add_u32 m0, s35, 28672
    s_nop 0
    buffer_load_dwordx4 v3, s[20:23], s37 offen offset:0 sc1 lds
    v_fmac_f32 v51, s40, v159
    v_fmac_f32 v84, s41, v156
    s_add_u32 m0, s35, 28672
    s_nop 0
    buffer_load_dwordx4 v3, s[20:23], s37 offen offset:1024 sc1 lds
    v_fmac_f32 v85, s41, v157
    v_fmac_f32 v86, s41, v158
    s_add_u32 m0, s35, 28672
    s_nop 0
    buffer_load_dwordx4 v3, s[20:23], s37 offen offset:2048 sc1 lds
    v_fmac_f32 v87, s41, v159
    v_fmac_f32 v120, s42, v156
    s_add_u32 m0, s35, 28672
    s_nop 0
    buffer_load_dwordx4 v3, s[20:23], s37 offen offset:3072 sc1 lds
    v_fmac_f32 v121, s42, v157
    v_fmac_f32 v122, s42, v158
    s_add_u32 m0, s35, 32768
    s_nop 0
    buffer_load_dwordx4 v13, s[20:23], s37 offen offset:0 sc1 lds
    v_fmac_f32 v123, s42, v159
    v_fmac_f32 v52, s40, v160
    s_add_u32 m0, s35, 32768
    s_nop 0
    buffer_load_dwordx4 v13, s[20:23], s37 offen offset:1024 sc1 lds
    s_add_u32 s37, s37, 24576
    v_fmac_f32 v53, s40, v161
    v_fmac_f32 v54, s40, v162
    v_fmac_f32 v55, s40, v163
    s_waitcnt vmcnt(13)
    s_barrier
    s_add_u32 m0, s34, 53248
    s_nop 0
    buffer_load_dwordx4 v3, s[20:23], s36 offen offset:0 sc1 lds
    v_fmac_f32 v88, s41, v160
    v_fmac_f32 v89, s41, v161
    v_fmac_f32 v90, s41, v162
    v_fmac_f32 v91, s41, v163
    v_fmac_f32 v124, s42, v160
    s_add_u32 m0, s34, 53248
    s_nop 0
    buffer_load_dwordx4 v3, s[20:23], s36 offen offset:1024 sc1 lds
    v_fmac_f32 v125, s42, v161
    v_fmac_f32 v126, s42, v162
    v_fmac_f32 v127, s42, v163
    v_fmac_f32 v56, s40, v164
    v_fmac_f32 v57, s40, v165
    s_add_u32 m0, s34, 53248
    s_nop 0
    buffer_load_dwordx4 v3, s[20:23], s36 offen offset:2048 sc1 lds
    v_fmac_f32 v58, s40, v166
    v_fmac_f32 v59, s40, v167
    v_fmac_f32 v92, s41, v164
    v_fmac_f32 v93, s41, v165
    v_fmac_f32 v94, s41, v166
    s_add_u32 m0, s34, 53248
    s_nop 0
    buffer_load_dwordx4 v3, s[20:23], s36 offen offset:3072 sc1 lds
    v_fmac_f32 v95, s41, v167
    v_fmac_f32 v128, s42, v164
    v_fmac_f32 v129, s42, v165
    v_fmac_f32 v130, s42, v166
    v_fmac_f32 v131, s42, v167
    s_add_u32 m0, s34, 57344
    s_nop 0
    buffer_load_dwordx4 v13, s[20:23], s36 offen offset:0 sc1 lds
    v_fmac_f32 v60, s40, v168
    v_fmac_f32 v61, s40, v169
    v_fmac_f32 v62, s40, v170
    v_fmac_f32 v63, s40, v171
    v_fmac_f32 v96, s41, v168
    v_fmac_f32 v97, s41, v169
    s_add_u32 m0, s34, 57344
    s_nop 0
    buffer_load_dwordx4 v6, s[20:23], s36 offen offset:1024 sc1 lds
    v_fmac_f32 v98, s41, v170
    v_fmac_f32 v99, s41, v171
    v_fmac_f32 v132, s42, v168
    v_fmac_f32 v133, s42, v169
    v_fmac_f32 v134, s42, v170
    s_add_u32 m0, s34, 57344
    s_nop 0
    buffer_load_dwordx4 v7, s[20:23], s36 offen offset:2048 sc1 lds
    s_add_u32 s36, s36, 195072
    v_fmac_f32 v135, s42, v171
    v_fmac_f32 v64, s40, v172
    v_fmac_f32 v65, s40, v173
    v_fmac_f32 v66, s40, v174
    v_fmac_f32 v67, s40, v175
    s_add_u32 m0, s35, 81920
    s_nop 0
    buffer_load_dwordx4 v3, s[20:23], s37 offen offset:0 sc1 lds
    v_fmac_f32 v100, s41, v172
    v_fmac_f32 v101, s41, v173
    v_fmac_f32 v102, s41, v174
    v_fmac_f32 v103, s41, v175
    v_fmac_f32 v136, s42, v172
    s_add_u32 m0, s35, 81920
    s_nop 0
    buffer_load_dwordx4 v3, s[20:23], s37 offen offset:1024 sc1 lds
    v_fmac_f32 v137, s42, v173
    v_fmac_f32 v138, s42, v174
    v_fmac_f32 v139, s42, v175
    v_fmac_f32 v68, s40, v176
    v_fmac_f32 v69, s40, v177
    v_fmac_f32 v70, s40, v178
    s_add_u32 m0, s35, 81920
    s_nop 0
    buffer_load_dwordx4 v3, s[20:23], s37 offen offset:2048 sc1 lds
    v_fmac_f32 v71, s40, v179
    v_fmac_f32 v104, s41, v176
    v_fmac_f32 v105, s41, v177
    v_fmac_f32 v106, s41, v178
    v_fmac_f32 v107, s41, v179
    s_add_u32 m0, s35, 81920
    s_nop 0
    buffer_load_dwordx4 v3, s[20:23], s37 offen offset:3072 sc1 lds
    v_fmac_f32 v140, s42, v176
    v_fmac_f32 v141, s42, v177
    v_fmac_f32 v142, s42, v178
    v_fmac_f32 v143, s42, v179
    v_fmac_f32 v72, s40, v180
    s_add_u32 m0, s35, 86016
    s_nop 0
    buffer_load_dwordx4 v13, s[20:23], s37 offen offset:0 sc1 lds
    v_fmac_f32 v73, s40, v181
    v_fmac_f32 v74, s40, v182
    v_fmac_f32 v75, s40, v183
    v_fmac_f32 v108, s41, v180
    v_fmac_f32 v109, s41, v181
    s_add_u32 m0, s35, 86016
    s_nop 0
    buffer_load_dwordx4 v13, s[20:23], s37 offen offset:1024 sc1 lds
    s_add_u32 s37, s37, 24576
    v_fmac_f32 v110, s41, v182
    v_fmac_f32 v111, s41, v183
    v_fmac_f32 v144, s42, v180
    v_fmac_f32 v145, s42, v181
    v_fmac_f32 v146, s42, v182
    v_fmac_f32 v147, s42, v183
    s_mov_b32 s40, s43
    s_mov_b32 s41, s44
    s_mov_b32 s42, s45
    s_mov_b32 s43, s46
    s_mov_b32 s44, s47
    s_mov_b32 s45, s48
    s_mov_b32 s46, s49
    s_mov_b32 s47, s50
    s_mov_b32 s48, s51
    s_mov_b32 s49, s52
    s_mov_b32 s50, s53
    s_mov_b32 s51, s54
    s_mov_b32 s52, s55
    s_mov_b32 s53, s56
    s_mov_b32 s54, s57
    s_waitcnt vmcnt(13)
    s_barrier
    s_lshl_b32 s30, s2, 3
    s_add_u32 s30, s30, s26
    s_cmp_lg_u32 s30, 4
    s_cbranch_scc1 L_nocl
    v_mov_b32 v24, 0
    v_mov_b32 v25, 0
    s_mov_b64 exec, 1
    buffer_store_dwordx2 v[24:25], v37, s[16:19], 0 offen sc1
    s_mov_b64 exec, -1
L_nocl:
    s_barrier
    ds_read_b128 v[148:151], v4 offset:0
    ds_read_b128 v[152:155], v4 offset:1024
    ds_read_b128 v[156:159], v4 offset:2048
    ds_read_b128 v[160:163], v4 offset:3072
    ds_read_b128 v[164:167], v4 offset:4096
    ds_read_b128 v[168:171], v4 offset:5120
    ds_read_b128 v[172:175], v4 offset:6144
    ds_read_b128 v[176:179], v5 offset:0
    ds_read_b128 v[180:183], v5 offset:1024
    s_waitcnt lgkmcnt(0)
    s_add_u32 m0, s34, 106496
    s_nop 0
    buffer_load_dwordx4 v3, s[20:23], s36 offen offset:0 sc1 lds
    s_add_u32 m0, s34, 106496
    s_nop 0
    buffer_load_dwordx4 v3, s[20:23], s36 offen offset:1024 sc1 lds
    s_add_u32 m0, s34, 106496
    s_nop 0
    buffer_load_dwordx4 v3, s[20:23], s36 offen offset:2048 sc1 lds
    s_add_u32 m0, s34, 106496
    s_nop 0
    buffer_load_dwordx4 v3, s[20:23], s36 offen offset:3072 sc1 lds
    s_add_u32 m0, s34, 110592
    s_nop 0
    buffer_load_dwordx4 v13, s[20:23], s36 offen offset:0 sc1 lds
    s_add_u32 m0, s34, 110592
    s_nop 0
    buffer_load_dwordx4 v6, s[20:23], s36 offen offset:1024 sc1 lds
    s_add_u32 m0, s34, 110592
    s_nop 0
    buffer_load_dwordx4 v7, s[20:23], s36 offen offset:2048 sc1 lds
    s_add_u32 s36, s36, 195072
    s_waitcnt vmcnt(7)
    s_barrier
    s_add_u32 m0, s35, 135168
    s_nop 0
    buffer_load_dwordx4 v3, s[20:23], s37 offen offset:0 sc1 lds
    v_fmac_f32 v40, s40, v148
    v_fmac_f32 v41, s40, v149
    s_add_u32 m0, s35, 135168
    s_nop 0
    buffer_load_dwordx4 v3, s[20:23], s37 offen offset:1024 sc1 lds
    v_fmac_f32 v42, s40, v150
    v_fmac_f32 v43, s40, v151
    s_add_u32 m0, s35, 135168
    s_nop 0
    buffer_load_dwordx4 v3, s[20:23], s37 offen offset:2048 sc1 lds
    v_fmac_f32 v112, s42, v148
    v_fmac_f32 v113, s42, v149
    s_add_u32 m0, s35, 135168
    s_nop 0
    buffer_load_dwordx4 v3, s[20:23], s37 offen offset:3072 sc1 lds
    v_fmac_f32 v114, s42, v150
    v_fmac_f32 v115, s42, v151
    s_add_u32 m0, s35, 139264
    s_nop 0
    buffer_load_dwordx4 v13, s[20:23], s37 offen offset:0 sc1 lds
    v_fmac_f32 v44, s40, v152
    v_fmac_f32 v45, s40, v153
    s_add_u32 m0, s35, 139264
    s_nop 0
    buffer_load_dwordx4 v13, s[20:23], s37 offen offset:1024 sc1 lds
    s_add_u32 s37, s37, 24576
    v_fmac_f32 v46, s40, v154
    v_fmac_f32 v47, s40, v155
    s_add_u32 m0, s34, 0
    s_nop 0
    buffer_load_dwordx4 v3, s[20:23], s36 offen offset:0 sc1 lds
    v_fmac_f32 v116, s42, v152
    v_fmac_f32 v117, s42, v153
    s_add_u32 m0, s34, 0
    s_nop 0
    buffer_load_dwordx4 v3, s[20:23], s36 offen offset:1024 sc1 lds
    v_fmac_f32 v118, s42, v154
    v_fmac_f32 v119, s42, v155
    s_add_u32 m0, s34, 0
    s_nop 0
    buffer_load_dwordx4 v3, s[20:23], s36 offen offset:2048 sc1 lds
    v_fmac_f32 v48, s40, v156
    v_fmac_f32 v49, s40, v157
    s_add_u32 m0, s34, 0
    s_nop 0
    buffer_load_dwordx4 v3, s[20:23], s36 offen offset:3072 sc1 lds
    v_fmac_f32 v50, s40, v158
    v_fmac_f32 v51, s40, v159
    v_fmac_f32 v120, s42, v156
    s_add_u32 m0, s34, 4096
    s_nop 0
    buffer_load_dwordx4 v13, s[20:23], s36 offen offset:0 sc1 lds
    v_fmac_f32 v121, s42, v157
    v_fmac_f32 v122, s42, v158
    s_add_u32 m0, s34, 4096
    s_nop 0
    buffer_load_dwordx4 v6, s[20:23], s36 offen offset:1024 sc1 lds
    v_fmac_f32 v123, s42, v159
    v_fmac_f32 v52, s40, v160
    s_add_u32 m0, s34, 4096
    s_nop 0
    buffer_load_dwordx4 v7, s[20:23], s36 offen offset:2048 sc1 lds
    s_add_u32 s36, s36, 195072
    v_fmac_f32 v53, s40, v161
    v_fmac_f32 v54, s40, v162
    s_add_u32 m0, s35, 28672
    s_nop 0
    buffer_load_dwordx4 v3, s[20:23], s37 offen offset:0 sc1 lds
    v_fmac_f32 v55, s40, v163
    v_fmac_f32 v124, s42, v160
    s_add_u32 m0, s35, 28672
    s_nop 0
    buffer_load_dwordx4 v3, s[20:23], s37 offen offset:1024 sc1 lds
    v_fmac_f32 v125, s42, v161
    v_fmac_f32 v126, s42, v162
    s_add_u32 m0, s35, 28672
    s_nop 0
    buffer_load_dwordx4 v3, s[20:23], s37 offen offset:2048 sc1 lds
    v_fmac_f32 v127, s42, v163
    v_fmac_f32 v56, s40, v164
    s_add_u32 m0, s35, 28672
    s_nop 0
    buffer_load_dwordx4 v3, s[20:23], s37 offen offset:3072 sc1 lds
    v_fmac_f32 v57, s40, v165
    v_fmac_f32 v58, s40, v166
    s_add_u32 m0, s35, 32768
    s_nop 0
    buffer_load_dwordx4 v13, s[20:23], s37 offen offset:0 sc1 lds
    v_fmac_f32 v59, s40, v167
    v_fmac_f32 v128, s42, v164
    s_add_u32 m0, s35, 32768
    s_nop 0
    buffer_load_dwordx4 v13, s[20:23], s37 offen offset:1024 sc1 lds
    s_add_u32 s37, s37, 24576
    v_fmac_f32 v129, s42, v165
    v_fmac_f32 v130, s42, v166
    v_fmac_f32 v131, s42, v167
    s_waitcnt vmcnt(13)
    s_barrier
    s_add_u32 m0, s34, 53248
    s_nop 0
    buffer_load_dwordx4 v3, s[20:23], s36 offen offset:0 sc1 lds
    v_fmac_f32 v60, s40, v168
    v_fmac_f32 v61, s40, v169
    s_add_u32 m0, s34, 53248
    s_nop 0
    buffer_load_dwordx4 v3, s[20:23], s36 offen offset:1024 sc1 lds
    v_fmac_f32 v62, s40, v170
    v_fmac_f32 v63, s40, v171
    s_add_u32 m0, s34, 53248
    s_nop 0
    buffer_load_dwordx4 v3, s[20:23], s36 offen offset:2048 sc1 lds
    v_fmac_f32 v132, s42, v168
    v_fmac_f32 v133, s42, v169
    v_fmac_f32 v134, s42, v170
    s_add_u32 m0, s34, 53248
    s_nop 0
    buffer_load_dwordx4 v3, s[20:23], s36 offen offset:3072 sc1 lds
    v_fmac_f32 v135, s42, v171
    v_fmac_f32 v64, s40, v172
    s_add_u32 m0, s34, 57344
    s_nop 0
    buffer_load_dwordx4 v13, s[20:23], s36 offen offset:0 sc1 lds
    v_fmac_f32 v65, s40, v173
    v_fmac_f32 v66, s40, v174
    v_fmac_f32 v67, s40, v175
    s_add_u32 m0, s34, 57344
    s_nop 0
    buffer_load_dwordx4 v6, s[20:23], s36 offen offset:1024 sc1 lds
    v_fmac_f32 v136, s42, v172
    v_fmac_f32 v137, s42, v173
    s_add_u32 m0, s34, 57344
    s_nop 0
    buffer_load_dwordx4 v7, s[20:23], s36 offen offset:2048 sc1 lds
    s_add_u32 s36, s36, 195072
    v_fmac_f32 v138, s42, v174
    v_fmac_f32 v139, s42, v175
    v_fmac_f32 v68, s40, v176
    s_add_u32 m0, s35, 81920
    s_nop 0
    buffer_load_dwordx4 v3, s[20:23], s37 offen offset:0 sc1 lds
    v_fmac_f32 v69, s40, v177
    v_fmac_f32 v70, s40, v178
    s_add_u32 m0, s35, 81920
    s_nop 0
    buffer_load_dwordx4 v3, s[20:23], s37 offen offset:1024 sc1 lds
    v_fmac_f32 v71, s40, v179
    v_fmac_f32 v140, s42, v176
    v_fmac_f32 v141, s42, v177
    s_add_u32 m0, s35, 81920
    s_nop 0
    buffer_load_dwordx4 v3, s[20:23], s37 offen offset:2048 sc1 lds
    v_fmac_f32 v142, s42, v178
    v_fmac_f32 v143, s42, v179
    s_add_u32 m0, s35, 81920
    s_nop 0
    buffer_load_dwordx4 v3, s[20:23], s37 offen offset:3072 sc1 lds
    v_fmac_f32 v72, s40, v180
    v_fmac_f32 v73, s40, v181
    v_fmac_f32 v74, s40, v182
    s_add_u32 m0, s35, 86016
    s_nop 0
    buffer_load_dwordx4 v13, s[20:23], s37 offen offset:0 sc1 lds
    v_fmac_f32 v75, s40, v183
    v_fmac_f32 v144, s42, v180
    s_add_u32 m0, s35, 86016
    s_nop 0
    buffer_load_dwordx4 v13, s[20:23], s37 offen offset:1024 sc1 lds
    s_add_u32 s37, s37, 24576
    v_fmac_f32 v145, s42, v181
    v_fmac_f32 v146, s42, v182
    v_fmac_f32 v147, s42, v183
    s_mov_b32 s40, s43
    s_mov_b32 s41, s44
    s_mov_b32 s42, s45
    s_mov_b32 s43, s46
    s_mov_b32 s44, s47
    s_mov_b32 s45, s48
    s_mov_b32 s46, s49
    s_mov_b32 s47, s50
    s_mov_b32 s48, s51
    s_mov_b32 s49, s52
    s_mov_b32 s50, s53
    s_mov_b32 s51, s54
    s_mov_b32 s52, s55
    s_mov_b32 s53, s56
    s_mov_b32 s54, s57
    s_waitcnt vmcnt(13)
    s_barrier
    s_barrier
    ds_read_b128 v[148:151], v4 offset:0
    ds_read_b128 v[152:155], v4 offset:1024
    ds_read_b128 v[156:159], v4 offset:2048
    ds_read_b128 v[160:163], v4 offset:3072
    ds_read_b128 v[164:167], v4 offset:4096
    ds_read_b128 v[168:171], v4 offset:5120
    ds_read_b128 v[172:175], v4 offset:6144
    ds_read_b128 v[176:179], v5 offset:0
    ds_read_b128 v[180:183], v5 offset:1024
    s_waitcnt lgkmcnt(0)
    s_add_u32 m0, s34, 106496
    s_nop 0
    buffer_load_dwordx4 v3, s[20:23], s36 offen offset:0 sc1 lds
    v_fmac_f32 v40, s40, v148
    v_fmac_f32 v41, s40, v149
    v_fmac_f32 v42, s40, v150
    v_fmac_f32 v43, s40, v151
    s_add_u32 m0, s34, 106496
    s_nop 0
    buffer_load_dwordx4 v3, s[20:23], s36 offen offset:1024 sc1 lds
    v_fmac_f32 v76, s41, v148
    v_fmac_f32 v77, s41, v149
    v_fmac_f32 v78, s41, v150
    v_fmac_f32 v79, s41, v151
    s_add_u32 m0, s34, 106496
    s_nop 0
    buffer_load_dwordx4 v3, s[20:23], s36 offen offset:2048 sc1 lds
    v_fmac_f32 v112, s42, v148
    v_fmac_f32 v113, s42, v149
    v_fmac_f32 v114, s42, v150
    v_fmac_f32 v115, s42, v151
    s_add_u32 m0, s34, 106496
    s_nop 0
    buffer_load_dwordx4 v3, s[20:23], s36 offen offset:3072 sc1 lds
    v_fmac_f32 v44, s40, v152
    v_fmac_f32 v45, s40, v153
    v_fmac_f32 v46, s40, v154
    v_fmac_f32 v47, s40, v155
    v_fmac_f32 v80, s41, v152
    s_add_u32 m0, s34, 110592
    s_nop 0
    buffer_load_dwordx4 v13, s[20:23], s36 offen offset:0 sc1 lds
    v_fmac_f32 v81, s41, v153
    v_fmac_f32 v82, s41, v154
    v_fmac_f32 v83, s41, v155
    v_fmac_f32 v116, s42, v152
    s_add_u32 m0, s34, 110592
    s_nop 0
    buffer_load_dwordx4 v6, s[20:23], s36 offen offset:1024 sc1 lds
    v_fmac_f32 v117, s42, v153
    v_fmac_f32 v118, s42, v154
    v_fmac_f32 v119, s42, v155
    v_fmac_f32 v48, s40, v156
    s_add_u32 m0, s34, 110592
    s_nop 0
    buffer_load_dwordx4 v7, s[20:23], s36 offen offset:2048 sc1 lds
    s_add_u32 s36, s36, 195072
    v_fmac_f32 v49, s40, v157
    v_fmac_f32 v50, s40, v158
    v_fmac_f32 v51, s40, v159
    v_fmac_f32 v84, s41, v156
    v_fmac_f32 v85, s41, v157
    s_waitcnt vmcnt(7)
    s_barrier
    s_mul_i32 s61, s24, 12288
    s_add_u32 s60, s61, 30451712
    s_add_u32 m0, s35, 135168
    s_nop 0
    buffer_load_dwordx4 v3, s[20:23], s37 offen offset:0 sc1 lds
    v_fmac_f32 v86, s41, v158
    v_fmac_f32 v87, s41, v159
    v_fmac_f32 v120, s42, v156
    v_fmac_f32 v121, s42, v157
    s_add_u32 m0, s35, 135168
    s_nop 0
    buffer_load_dwordx4 v3, s[20:23], s37 offen offset:1024 sc1 lds
    v_fmac_f32 v122, s42, v158
    v_fmac_f32 v123, s42, v159
    v_fmac_f32 v52, s40, v160
    v_fmac_f32 v53, s40, v161
    s_add_u32 m0, s35, 135168
    s_nop 0
    buffer_load_dwordx4 v3, s[20:23], s37 offen offset:2048 sc1 lds
    v_fmac_f32 v54, s40, v162
    v_fmac_f32 v55, s40, v163
    v_fmac_f32 v88, s41, v160
    v_fmac_f32 v89, s41, v161
    v_fmac_f32 v90, s41, v162
    s_add_u32 m0, s35, 135168
    s_nop 0
    buffer_load_dwordx4 v3, s[20:23], s37 offen offset:3072 sc1 lds
    v_fmac_f32 v91, s41, v163
    v_fmac_f32 v124, s42, v160
    v_fmac_f32 v125, s42, v161
    v_fmac_f32 v126, s42, v162
    s_add_u32 m0, s35, 139264
    s_nop 0
    buffer_load_dwordx4 v13, s[20:23], s37 offen offset:0 sc1 lds
    v_fmac_f32 v127, s42, v163
    v_fmac_f32 v56, s40, v164
    v_fmac_f32 v57, s40, v165
    v_fmac_f32 v58, s40, v166
    s_add_u32 m0, s35, 139264
    s_nop 0
    buffer_load_dwordx4 v13, s[20:23], s37 offen offset:1024 sc1 lds
    s_add_u32 s37, s37, 24576
    v_fmac_f32 v59, s40, v167
    v_fmac_f32 v92, s41, v164
    v_fmac_f32 v93, s41, v165
    v_fmac_f32 v94, s41, v166
    v_fmac_f32 v95, s41, v167
    s_add_u32 m0, s61, 0
    s_nop 0
    buffer_load_dwordx4 v3, s[20:23], s60 offen offset:0 sc1 lds
    v_fmac_f32 v128, s42, v164
    v_fmac_f32 v129, s42, v165
    v_fmac_f32 v130, s42, v166
    v_fmac_f32 v131, s42, v167
    s_add_u32 m0, s61, 0
    s_nop 0
    buffer_load_dwordx4 v3, s[20:23], s60 offen offset:1024 sc1 lds
    v_fmac_f32 v60, s40, v168
    v_fmac_f32 v61, s40, v169
    v_fmac_f32 v62, s40, v170
    v_fmac_f32 v63, s40, v171
    s_add_u32 m0, s61, 0
    s_nop 0
    buffer_load_dwordx4 v3, s[20:23], s60 offen offset:2048 sc1 lds
    v_fmac_f32 v96, s41, v168
    v_fmac_f32 v97, s41, v169
    v_fmac_f32 v98, s41, v170
    v_fmac_f32 v99, s41, v171
    v_fmac_f32 v132, s42, v168
    s_add_u32 m0, s61, 0
    s_nop 0
    buffer_load_dwordx4 v3, s[20:23], s60 offen offset:3072 sc1 lds
    s_add_u32 s60, s60, 4096
    v_fmac_f32 v133, s42, v169
    v_fmac_f32 v134, s42, v170
    v_fmac_f32 v135, s42, v171
    v_fmac_f32 v64, s40, v172
    s_add_u32 m0, s61, 4096
    s_nop 0
    buffer_load_dwordx4 v3, s[20:23], s60 offen offset:0 sc1 lds
    v_fmac_f32 v65, s40, v173
    v_fmac_f32 v66, s40, v174
    v_fmac_f32 v67, s40, v175
    v_fmac_f32 v100, s41, v172
    s_add_u32 m0, s61, 4096
    s_nop 0
    buffer_load_dwordx4 v3, s[20:23], s60 offen offset:1024 sc1 lds
    v_fmac_f32 v101, s41, v173
    v_fmac_f32 v102, s41, v174
    v_fmac_f32 v103, s41, v175
    v_fmac_f32 v136, s42, v172
    v_fmac_f32 v137, s42, v173
    s_add_u32 m0, s61, 4096
    s_nop 0
    buffer_load_dwordx4 v3, s[20:23], s60 offen offset:2048 sc1 lds
    v_fmac_f32 v138, s42, v174
    v_fmac_f32 v139, s42, v175
    v_fmac_f32 v68, s40, v176
    v_fmac_f32 v69, s40, v177
    s_add_u32 m0, s61, 4096
    s_nop 0
    buffer_load_dwordx4 v3, s[20:23], s60 offen offset:3072 sc1 lds
    s_add_u32 s60, s60, 4096
    v_fmac_f32 v70, s40, v178
    v_fmac_f32 v71, s40, v179
    v_fmac_f32 v104, s41, v176
    v_fmac_f32 v105, s41, v177
    s_add_u32 m0, s61, 8192
    s_nop 0
    buffer_load_dwordx4 v3, s[20:23], s60 offen offset:0 sc1 lds
    v_fmac_f32 v106, s41, v178
    v_fmac_f32 v107, s41, v179
    v_fmac_f32 v140, s42, v176
    v_fmac_f32 v141, s42, v177
    v_fmac_f32 v142, s42, v178
    s_add_u32 m0, s61, 8192
    s_nop 0
    buffer_load_dwordx4 v3, s[20:23], s60 offen offset:1024 sc1 lds
    v_fmac_f32 v143, s42, v179
    v_fmac_f32 v72, s40, v180
    v_fmac_f32 v73, s40, v181
    v_fmac_f32 v74, s40, v182
    s_add_u32 m0, s61, 8192
    s_nop 0
    buffer_load_dwordx4 v3, s[20:23], s60 offen offset:2048 sc1 lds
    v_fmac_f32 v75, s40, v183
    v_fmac_f32 v108, s41, v180
    v_fmac_f32 v109, s41, v181
    v_fmac_f32 v110, s41, v182
    s_add_u32 m0, s61, 8192
    s_nop 0
    buffer_load_dwordx4 v3, s[20:23], s60 offen offset:3072 sc1 lds
    s_add_u32 s60, s60, 4096
    v_fmac_f32 v111, s41, v183
    v_fmac_f32 v144, s42, v180
    v_fmac_f32 v145, s42, v181
    v_fmac_f32 v146, s42, v182
    v_fmac_f32 v147, s42, v183
    s_mov_b32 s46, 0xbf317218
    s_mov_b32 s42, 0x3a38aa3b
    s_mov_b32 s43, 0x41f00000
    s_mov_b32 s63, s62
    v_lshrrev_b32 v9, 2, v3
    v_min_f32 v184, s43, v40
    v_min_f32 v185, s43, v41
    v_exp_f32 v42, v42
    v_exp_f32 v43, v43
    v_exp_f32 v184, v184
    v_exp_f32 v185, v185
    v_cmp_gt_f32 s[48:49], s42, abs(v40)
    v_cmp_gt_f32 s[50:51], s42, abs(v41)
    v_add_f32 v186, 1.0, v184
    v_add_f32 v187, 1.0, v185
    v_mul_f32 v40, s46, v40
    v_mul_f32 v41, s46, v41
    v_fmac_f32 v186, v186, v42
    v_fmac_f32 v187, v187, v43
    v_sub_f32 v184, 1.0, v184
    v_sub_f32 v185, 1.0, v185
    v_rcp_f32 v186, v186
    v_rcp_f32 v187, v187
    v_cndmask_b32 v184, v184, v40, s[48:49]
    v_cndmask_b32 v185, v185, v41, s[50:51]
    v_mul_f32 v184, v184, v186
    v_mul_f32 v185, v185, v187
    v_cvt_pk_bf16_f32 v200, v184, v185
    s_add_u32 s63, s62, 0
    buffer_store_dword v200, v9, s[20:23], s63 offen sc1
    v_min_f32 v188, s43, v76
    v_min_f32 v189, s43, v77
    v_exp_f32 v78, v78
    v_exp_f32 v79, v79
    v_exp_f32 v188, v188
    v_exp_f32 v189, v189
    v_cmp_gt_f32 s[48:49], s42, abs(v76)
    v_cmp_gt_f32 s[50:51], s42, abs(v77)
    v_add_f32 v190, 1.0, v188
    v_add_f32 v191, 1.0, v189
    v_mul_f32 v76, s46, v76
    v_mul_f32 v77, s46, v77
    v_fmac_f32 v190, v190, v78
    v_fmac_f32 v191, v191, v79
    v_sub_f32 v188, 1.0, v188
    v_sub_f32 v189, 1.0, v189
    v_rcp_f32 v190, v190
    v_rcp_f32 v191, v191
    v_cndmask_b32 v188, v188, v76, s[48:49]
    v_cndmask_b32 v189, v189, v77, s[50:51]
    v_mul_f32 v188, v188, v190
    v_mul_f32 v189, v189, v191
    v_cvt_pk_bf16_f32 v201, v188, v189
    s_add_u32 s63, s62, 4608
    buffer_store_dword v201, v9, s[20:23], s63 offen sc1
    v_min_f32 v184, s43, v112
    v_min_f32 v185, s43, v113
    v_exp_f32 v114, v114
    v_exp_f32 v115, v115
    v_exp_f32 v184, v184
    v_exp_f32 v185, v185
    v_cmp_gt_f32 s[48:49], s42, abs(v112)
    v_cmp_gt_f32 s[50:51], s42, abs(v113)
    v_add_f32 v186, 1.0, v184
    v_add_f32 v187, 1.0, v185
    v_mul_f32 v112, s46, v112
    v_mul_f32 v113, s46, v113
    v_fmac_f32 v186, v186, v114
    v_fmac_f32 v187, v187, v115
    v_sub_f32 v184, 1.0, v184
    v_sub_f32 v185, 1.0, v185
    v_rcp_f32 v186, v186
    v_rcp_f32 v187, v187
    v_cndmask_b32 v184, v184, v112, s[48:49]
    v_cndmask_b32 v185, v185, v113, s[50:51]
    v_mul_f32 v184, v184, v186
    v_mul_f32 v185, v185, v187
    v_cvt_pk_bf16_f32 v202, v184, v185
    s_add_u32 s63, s62, 9216
    buffer_store_dword v202, v9, s[20:23], s63 offen sc1
    v_min_f32 v188, s43, v44
    v_min_f32 v189, s43, v45
    v_exp_f32 v46, v46
    v_exp_f32 v47, v47
    v_exp_f32 v188, v188
    v_exp_f32 v189, v189
    v_cmp_gt_f32 s[48:49], s42, abs(v44)
    v_cmp_gt_f32 s[50:51], s42, abs(v45)
    v_add_f32 v190, 1.0, v188
    v_add_f32 v191, 1.0, v189
    v_mul_f32 v44, s46, v44
    v_mul_f32 v45, s46, v45
    v_fmac_f32 v190, v190, v46
    v_fmac_f32 v191, v191, v47
    v_sub_f32 v188, 1.0, v188
    v_sub_f32 v189, 1.0, v189
    v_rcp_f32 v190, v190
    v_rcp_f32 v191, v191
    v_cndmask_b32 v188, v188, v44, s[48:49]
    v_cndmask_b32 v189, v189, v45, s[50:51]
    v_mul_f32 v188, v188, v190
    v_mul_f32 v189, v189, v191
    v_cvt_pk_bf16_f32 v203, v188, v189
    s_add_u32 s63, s62, 18432
    buffer_store_dword v203, v9, s[20:23], s63 offen sc1
    v_min_f32 v184, s43, v80
    v_min_f32 v185, s43, v81
    v_exp_f32 v82, v82
    v_exp_f32 v83, v83
    v_exp_f32 v184, v184
    v_exp_f32 v185, v185
    v_cmp_gt_f32 s[48:49], s42, abs(v80)
    v_cmp_gt_f32 s[50:51], s42, abs(v81)
    v_add_f32 v186, 1.0, v184
    v_add_f32 v187, 1.0, v185
    v_mul_f32 v80, s46, v80
    v_mul_f32 v81, s46, v81
    v_fmac_f32 v186, v186, v82
    v_fmac_f32 v187, v187, v83
    v_sub_f32 v184, 1.0, v184
    v_sub_f32 v185, 1.0, v185
    v_rcp_f32 v186, v186
    v_rcp_f32 v187, v187
    v_cndmask_b32 v184, v184, v80, s[48:49]
    v_cndmask_b32 v185, v185, v81, s[50:51]
    v_mul_f32 v184, v184, v186
    v_mul_f32 v185, v185, v187
    v_cvt_pk_bf16_f32 v204, v184, v185
    s_add_u32 s63, s62, 23040
    buffer_store_dword v204, v9, s[20:23], s63 offen sc1
    s_waitcnt vmcnt(17)
    s_barrier
    v_min_f32 v188, s43, v116
    v_min_f32 v189, s43, v117
    v_exp_f32 v118, v118
    v_exp_f32 v119, v119
    v_exp_f32 v188, v188
    v_exp_f32 v189, v189
    v_cmp_gt_f32 s[48:49], s42, abs(v116)
    v_cmp_gt_f32 s[50:51], s42, abs(v117)
    v_add_f32 v190, 1.0, v188
    v_add_f32 v191, 1.0, v189
    v_mul_f32 v116, s46, v116
    v_mul_f32 v117, s46, v117
    v_fmac_f32 v190, v190, v118
    v_fmac_f32 v191, v191, v119
    v_sub_f32 v188, 1.0, v188
    v_sub_f32 v189, 1.0, v189
    v_rcp_f32 v190, v190
    v_rcp_f32 v191, v191
    v_cndmask_b32 v188, v188, v116, s[48:49]
    v_cndmask_b32 v189, v189, v117, s[50:51]
    v_mul_f32 v188, v188, v190
    v_mul_f32 v189, v189, v191
    v_cvt_pk_bf16_f32 v205, v188, v189
    s_add_u32 s63, s62, 27648
    buffer_store_dword v205, v9, s[20:23], s63 offen sc1
    v_min_f32 v184, s43, v48
    v_min_f32 v185, s43, v49
    v_exp_f32 v50, v50
    v_exp_f32 v51, v51
    v_exp_f32 v184, v184
    v_exp_f32 v185, v185
    v_cmp_gt_f32 s[48:49], s42, abs(v48)
    v_cmp_gt_f32 s[50:51], s42, abs(v49)
    v_add_f32 v186, 1.0, v184
    v_add_f32 v187, 1.0, v185
    v_mul_f32 v48, s46, v48
    v_mul_f32 v49, s46, v49
    v_fmac_f32 v186, v186, v50
    v_fmac_f32 v187, v187, v51
    v_sub_f32 v184, 1.0, v184
    v_sub_f32 v185, 1.0, v185
    v_rcp_f32 v186, v186
    v_rcp_f32 v187, v187
    v_cndmask_b32 v184, v184, v48, s[48:49]
    v_cndmask_b32 v185, v185, v49, s[50:51]
    v_mul_f32 v184, v184, v186
    v_mul_f32 v185, v185, v187
    v_cvt_pk_bf16_f32 v206, v184, v185
    s_add_u32 s63, s62, 36864
    buffer_store_dword v206, v9, s[20:23], s63 offen sc1
    v_min_f32 v188, s43, v84
    v_min_f32 v189, s43, v85
    v_exp_f32 v86, v86
    v_exp_f32 v87, v87
    v_exp_f32 v188, v188
    v_exp_f32 v189, v189
    v_cmp_gt_f32 s[48:49], s42, abs(v84)
    v_cmp_gt_f32 s[50:51], s42, abs(v85)
    v_add_f32 v190, 1.0, v188
    v_add_f32 v191, 1.0, v189
    v_mul_f32 v84, s46, v84
    v_mul_f32 v85, s46, v85
    v_fmac_f32 v190, v190, v86
    v_fmac_f32 v191, v191, v87
    v_sub_f32 v188, 1.0, v188
    v_sub_f32 v189, 1.0, v189
    v_rcp_f32 v190, v190
    v_rcp_f32 v191, v191
    v_cndmask_b32 v188, v188, v84, s[48:49]
    v_cndmask_b32 v189, v189, v85, s[50:51]
    v_mul_f32 v188, v188, v190
    v_mul_f32 v189, v189, v191
    v_cvt_pk_bf16_f32 v207, v188, v189
    s_add_u32 s63, s62, 41472
    buffer_store_dword v207, v9, s[20:23], s63 offen sc1
    v_min_f32 v184, s43, v120
    v_min_f32 v185, s43, v121
    v_exp_f32 v122, v122
    v_exp_f32 v123, v123
    v_exp_f32 v184, v184
    v_exp_f32 v185, v185
    v_cmp_gt_f32 s[48:49], s42, abs(v120)
    v_cmp_gt_f32 s[50:51], s42, abs(v121)
    v_add_f32 v186, 1.0, v184
    v_add_f32 v187, 1.0, v185
    v_mul_f32 v120, s46, v120
    v_mul_f32 v121, s46, v121
    v_fmac_f32 v186, v186, v122
    v_fmac_f32 v187, v187, v123
    v_sub_f32 v184, 1.0, v184
    v_sub_f32 v185, 1.0, v185
    v_rcp_f32 v186, v186
    v_rcp_f32 v187, v187
    v_cndmask_b32 v184, v184, v120, s[48:49]
    v_cndmask_b32 v185, v185, v121, s[50:51]
    v_mul_f32 v184, v184, v186
    v_mul_f32 v185, v185, v187
    v_cvt_pk_bf16_f32 v208, v184, v185
    s_add_u32 s63, s62, 46080
    buffer_store_dword v208, v9, s[20:23], s63 offen sc1
    v_min_f32 v188, s43, v52
    v_min_f32 v189, s43, v53
    v_exp_f32 v54, v54
    v_exp_f32 v55, v55
    v_exp_f32 v188, v188
    v_exp_f32 v189, v189
    v_cmp_gt_f32 s[48:49], s42, abs(v52)
    v_cmp_gt_f32 s[50:51], s42, abs(v53)
    v_add_f32 v190, 1.0, v188
    v_add_f32 v191, 1.0, v189
    v_mul_f32 v52, s46, v52
    v_mul_f32 v53, s46, v53
    v_fmac_f32 v190, v190, v54
    v_fmac_f32 v191, v191, v55
    v_sub_f32 v188, 1.0, v188
    v_sub_f32 v189, 1.0, v189
    v_rcp_f32 v190, v190
    v_rcp_f32 v191, v191
    v_cndmask_b32 v188, v188, v52, s[48:49]
    v_cndmask_b32 v189, v189, v53, s[50:51]
    v_mul_f32 v188, v188, v190
    v_mul_f32 v189, v189, v191
    v_cvt_pk_bf16_f32 v209, v188, v189
    s_add_u32 s63, s62, 55296
    buffer_store_dword v209, v9, s[20:23], s63 offen sc1
    v_min_f32 v184, s43, v88
    v_min_f32 v185, s43, v89
    v_exp_f32 v90, v90
    v_exp_f32 v91, v91
    v_exp_f32 v184, v184
    v_exp_f32 v185, v185
    v_cmp_gt_f32 s[48:49], s42, abs(v88)
    v_cmp_gt_f32 s[50:51], s42, abs(v89)
    v_add_f32 v186, 1.0, v184
    v_add_f32 v187, 1.0, v185
    v_mul_f32 v88, s46, v88
    v_mul_f32 v89, s46, v89
    v_fmac_f32 v186, v186, v90
    v_fmac_f32 v187, v187, v91
    v_sub_f32 v184, 1.0, v184
    v_sub_f32 v185, 1.0, v185
    v_rcp_f32 v186, v186
    v_rcp_f32 v187, v187
    v_cndmask_b32 v184, v184, v88, s[48:49]
    v_cndmask_b32 v185, v185, v89, s[50:51]
    v_mul_f32 v184, v184, v186
    v_mul_f32 v185, v185, v187
    v_cvt_pk_bf16_f32 v210, v184, v185
    s_add_u32 s63, s62, 59904
    buffer_store_dword v210, v9, s[20:23], s63 offen sc1
    v_min_f32 v188, s43, v124
    v_min_f32 v189, s43, v125
    v_exp_f32 v126, v126
    v_exp_f32 v127, v127
    v_exp_f32 v188, v188
    v_exp_f32 v189, v189
    v_cmp_gt_f32 s[48:49], s42, abs(v124)
    v_cmp_gt_f32 s[50:51], s42, abs(v125)
    v_add_f32 v190, 1.0, v188
    v_add_f32 v191, 1.0, v189
    v_mul_f32 v124, s46, v124
    v_mul_f32 v125, s46, v125
    v_fmac_f32 v190, v190, v126
    v_fmac_f32 v191, v191, v127
    v_sub_f32 v188, 1.0, v188
    v_sub_f32 v189, 1.0, v189
    v_rcp_f32 v190, v190
    v_rcp_f32 v191, v191
    v_cndmask_b32 v188, v188, v124, s[48:49]
    v_cndmask_b32 v189, v189, v125, s[50:51]
    v_mul_f32 v188, v188, v190
    v_mul_f32 v189, v189, v191
    v_cvt_pk_bf16_f32 v211, v188, v189
    s_add_u32 s63, s62, 64512
    buffer_store_dword v211, v9, s[20:23], s63 offen sc1
    s_barrier
    v_min_f32 v184, s43, v56
    v_min_f32 v185, s43, v57
    v_exp_f32 v58, v58
    v_exp_f32 v59, v59
    v_exp_f32 v184, v184
    v_exp_f32 v185, v185
    v_cmp_gt_f32 s[48:49], s42, abs(v56)
    v_cmp_gt_f32 s[50:51], s42, abs(v57)
    v_add_f32 v186, 1.0, v184
    v_add_f32 v187, 1.0, v185
    v_mul_f32 v56, s46, v56
    v_mul_f32 v57, s46, v57
    v_fmac_f32 v186, v186, v58
    v_fmac_f32 v187, v187, v59
    v_sub_f32 v184, 1.0, v184
    v_sub_f32 v185, 1.0, v185
    v_rcp_f32 v186, v186
    v_rcp_f32 v187, v187
    v_cndmask_b32 v184, v184, v56, s[48:49]
    v_cndmask_b32 v185, v185, v57, s[50:51]
    v_mul_f32 v184, v184, v186
    v_mul_f32 v185, v185, v187
    v_cvt_pk_bf16_f32 v212, v184, v185
    s_add_u32 s63, s62, 73728
    buffer_store_dword v212, v9, s[20:23], s63 offen sc1
    v_min_f32 v188, s43, v92
    v_min_f32 v189, s43, v93
    v_exp_f32 v94, v94
    v_exp_f32 v95, v95
    v_exp_f32 v188, v188
    v_exp_f32 v189, v189
    v_cmp_gt_f32 s[48:49], s42, abs(v92)
    v_cmp_gt_f32 s[50:51], s42, abs(v93)
    v_add_f32 v190, 1.0, v188
    v_add_f32 v191, 1.0, v189
    v_mul_f32 v92, s46, v92
    v_mul_f32 v93, s46, v93
    v_fmac_f32 v190, v190, v94
    v_fmac_f32 v191, v191, v95
    v_sub_f32 v188, 1.0, v188
    v_sub_f32 v189, 1.0, v189
    v_rcp_f32 v190, v190
    v_rcp_f32 v191, v191
    v_cndmask_b32 v188, v188, v92, s[48:49]
    v_cndmask_b32 v189, v189, v93, s[50:51]
    v_mul_f32 v188, v188, v190
    v_mul_f32 v189, v189, v191
    v_cvt_pk_bf16_f32 v213, v188, v189
    s_add_u32 s63, s62, 78336
    buffer_store_dword v213, v9, s[20:23], s63 offen sc1
    v_min_f32 v184, s43, v128
    v_min_f32 v185, s43, v129
    v_exp_f32 v130, v130
    v_exp_f32 v131, v131
    v_exp_f32 v184, v184
    v_exp_f32 v185, v185
    v_cmp_gt_f32 s[48:49], s42, abs(v128)
    v_cmp_gt_f32 s[50:51], s42, abs(v129)
    v_add_f32 v186, 1.0, v184
    v_add_f32 v187, 1.0, v185
    v_mul_f32 v128, s46, v128
    v_mul_f32 v129, s46, v129
    v_fmac_f32 v186, v186, v130
    v_fmac_f32 v187, v187, v131
    v_sub_f32 v184, 1.0, v184
    v_sub_f32 v185, 1.0, v185
    v_rcp_f32 v186, v186
    v_rcp_f32 v187, v187
    v_cndmask_b32 v184, v184, v128, s[48:49]
    v_cndmask_b32 v185, v185, v129, s[50:51]
    v_mul_f32 v184, v184, v186
    v_mul_f32 v185, v185, v187
    v_cvt_pk_bf16_f32 v214, v184, v185
    s_add_u32 s63, s62, 82944
    buffer_store_dword v214, v9, s[20:23], s63 offen sc1
    v_min_f32 v188, s43, v60
    v_min_f32 v189, s43, v61
    v_exp_f32 v62, v62
    v_exp_f32 v63, v63
    v_exp_f32 v188, v188
    v_exp_f32 v189, v189
    v_cmp_gt_f32 s[48:49], s42, abs(v60)
    v_cmp_gt_f32 s[50:51], s42, abs(v61)
    v_add_f32 v190, 1.0, v188
    v_add_f32 v191, 1.0, v189
    v_mul_f32 v60, s46, v60
    v_mul_f32 v61, s46, v61
    v_fmac_f32 v190, v190, v62
    v_fmac_f32 v191, v191, v63
    v_sub_f32 v188, 1.0, v188
    v_sub_f32 v189, 1.0, v189
    v_rcp_f32 v190, v190
    v_rcp_f32 v191, v191
    v_cndmask_b32 v188, v188, v60, s[48:49]
    v_cndmask_b32 v189, v189, v61, s[50:51]
    v_mul_f32 v188, v188, v190
    v_mul_f32 v189, v189, v191
    v_cvt_pk_bf16_f32 v215, v188, v189
    s_add_u32 s63, s62, 92160
    buffer_store_dword v215, v9, s[20:23], s63 offen sc1
    v_min_f32 v184, s43, v96
    v_min_f32 v185, s43, v97
    v_exp_f32 v98, v98
    v_exp_f32 v99, v99
    v_exp_f32 v184, v184
    v_exp_f32 v185, v185
    v_cmp_gt_f32 s[48:49], s42, abs(v96)
    v_cmp_gt_f32 s[50:51], s42, abs(v97)
    v_add_f32 v186, 1.0, v184
    v_add_f32 v187, 1.0, v185
    v_mul_f32 v96, s46, v96
    v_mul_f32 v97, s46, v97
    v_fmac_f32 v186, v186, v98
    v_fmac_f32 v187, v187, v99
    v_sub_f32 v184, 1.0, v184
    v_sub_f32 v185, 1.0, v185
    v_rcp_f32 v186, v186
    v_rcp_f32 v187, v187
    v_cndmask_b32 v184, v184, v96, s[48:49]
    v_cndmask_b32 v185, v185, v97, s[50:51]
    v_mul_f32 v184, v184, v186
    v_mul_f32 v185, v185, v187
    v_cvt_pk_bf16_f32 v216, v184, v185
    s_add_u32 s63, s62, 96768
    buffer_store_dword v216, v9, s[20:23], s63 offen sc1
    v_min_f32 v188, s43, v132
    v_min_f32 v189, s43, v133
    v_exp_f32 v134, v134
    v_exp_f32 v135, v135
    v_exp_f32 v188, v188
    v_exp_f32 v189, v189
    v_cmp_gt_f32 s[48:49], s42, abs(v132)
    v_cmp_gt_f32 s[50:51], s42, abs(v133)
    v_add_f32 v190, 1.0, v188
    v_add_f32 v191, 1.0, v189
    v_mul_f32 v132, s46, v132
    v_mul_f32 v133, s46, v133
    v_fmac_f32 v190, v190, v134
    v_fmac_f32 v191, v191, v135
    v_sub_f32 v188, 1.0, v188
    v_sub_f32 v189, 1.0, v189
    v_rcp_f32 v190, v190
    v_rcp_f32 v191, v191
    v_cndmask_b32 v188, v188, v132, s[48:49]
    v_cndmask_b32 v189, v189, v133, s[50:51]
    v_mul_f32 v188, v188, v190
    v_mul_f32 v189, v189, v191
    v_cvt_pk_bf16_f32 v217, v188, v189
    s_add_u32 s63, s62, 101376
    buffer_store_dword v217, v9, s[20:23], s63 offen sc1
    v_min_f32 v184, s43, v64
    v_min_f32 v185, s43, v65
    v_exp_f32 v66, v66
    v_exp_f32 v67, v67
    v_exp_f32 v184, v184
    v_exp_f32 v185, v185
    v_cmp_gt_f32 s[48:49], s42, abs(v64)
    v_cmp_gt_f32 s[50:51], s42, abs(v65)
    v_add_f32 v186, 1.0, v184
    v_add_f32 v187, 1.0, v185
    v_mul_f32 v64, s46, v64
    v_mul_f32 v65, s46, v65
    v_fmac_f32 v186, v186, v66
    v_fmac_f32 v187, v187, v67
    v_sub_f32 v184, 1.0, v184
    v_sub_f32 v185, 1.0, v185
    v_rcp_f32 v186, v186
    v_rcp_f32 v187, v187
    v_cndmask_b32 v184, v184, v64, s[48:49]
    v_cndmask_b32 v185, v185, v65, s[50:51]
    v_mul_f32 v184, v184, v186
    v_mul_f32 v185, v185, v187
    v_cvt_pk_bf16_f32 v218, v184, v185
    s_add_u32 s63, s62, 110592
    buffer_store_dword v218, v9, s[20:23], s63 offen sc1
    v_min_f32 v188, s43, v100
    v_min_f32 v189, s43, v101
    v_exp_f32 v102, v102
    v_exp_f32 v103, v103
    v_exp_f32 v188, v188
    v_exp_f32 v189, v189
    v_cmp_gt_f32 s[48:49], s42, abs(v100)
    v_cmp_gt_f32 s[50:51], s42, abs(v101)
    v_add_f32 v190, 1.0, v188
    v_add_f32 v191, 1.0, v189
    v_mul_f32 v100, s46, v100
    v_mul_f32 v101, s46, v101
    v_fmac_f32 v190, v190, v102
    v_fmac_f32 v191, v191, v103
    v_sub_f32 v188, 1.0, v188
    v_sub_f32 v189, 1.0, v189
    v_rcp_f32 v190, v190
    v_rcp_f32 v191, v191
    v_cndmask_b32 v188, v188, v100, s[48:49]
    v_cndmask_b32 v189, v189, v101, s[50:51]
    v_mul_f32 v188, v188, v190
    v_mul_f32 v189, v189, v191
    v_cvt_pk_bf16_f32 v219, v188, v189
    s_add_u32 s63, s62, 115200
    buffer_store_dword v219, v9, s[20:23], s63 offen sc1
    v_min_f32 v184, s43, v136
    v_min_f32 v185, s43, v137
    v_exp_f32 v138, v138
    v_exp_f32 v139, v139
    v_exp_f32 v184, v184
    v_exp_f32 v185, v185
    v_cmp_gt_f32 s[48:49], s42, abs(v136)
    v_cmp_gt_f32 s[50:51], s42, abs(v137)
    v_add_f32 v186, 1.0, v184
    v_add_f32 v187, 1.0, v185
    v_mul_f32 v136, s46, v136
    v_mul_f32 v137, s46, v137
    v_fmac_f32 v186, v186, v138
    v_fmac_f32 v187, v187, v139
    v_sub_f32 v184, 1.0, v184
    v_sub_f32 v185, 1.0, v185
    v_rcp_f32 v186, v186
    v_rcp_f32 v187, v187
    v_cndmask_b32 v184, v184, v136, s[48:49]
    v_cndmask_b32 v185, v185, v137, s[50:51]
    v_mul_f32 v184, v184, v186
    v_mul_f32 v185, v185, v187
    v_cvt_pk_bf16_f32 v220, v184, v185
    s_add_u32 s63, s62, 119808
    buffer_store_dword v220, v9, s[20:23], s63 offen sc1
    v_min_f32 v188, s43, v68
    v_min_f32 v189, s43, v69
    v_exp_f32 v70, v70
    v_exp_f32 v71, v71
    v_exp_f32 v188, v188
    v_exp_f32 v189, v189
    v_cmp_gt_f32 s[48:49], s42, abs(v68)
    v_cmp_gt_f32 s[50:51], s42, abs(v69)
    v_add_f32 v190, 1.0, v188
    v_add_f32 v191, 1.0, v189
    v_mul_f32 v68, s46, v68
    v_mul_f32 v69, s46, v69
    v_fmac_f32 v190, v190, v70
    v_fmac_f32 v191, v191, v71
    v_sub_f32 v188, 1.0, v188
    v_sub_f32 v189, 1.0, v189
    v_rcp_f32 v190, v190
    v_rcp_f32 v191, v191
    v_cndmask_b32 v188, v188, v68, s[48:49]
    v_cndmask_b32 v189, v189, v69, s[50:51]
    v_mul_f32 v188, v188, v190
    v_mul_f32 v189, v189, v191
    v_cvt_pk_bf16_f32 v221, v188, v189
    s_add_u32 s63, s62, 129024
    buffer_store_dword v221, v9, s[20:23], s63 offen sc1
    v_min_f32 v184, s43, v104
    v_min_f32 v185, s43, v105
    v_exp_f32 v106, v106
    v_exp_f32 v107, v107
    v_exp_f32 v184, v184
    v_exp_f32 v185, v185
    v_cmp_gt_f32 s[48:49], s42, abs(v104)
    v_cmp_gt_f32 s[50:51], s42, abs(v105)
    v_add_f32 v186, 1.0, v184
    v_add_f32 v187, 1.0, v185
    v_mul_f32 v104, s46, v104
    v_mul_f32 v105, s46, v105
    v_fmac_f32 v186, v186, v106
    v_fmac_f32 v187, v187, v107
    v_sub_f32 v184, 1.0, v184
    v_sub_f32 v185, 1.0, v185
    v_rcp_f32 v186, v186
    v_rcp_f32 v187, v187
    v_cndmask_b32 v184, v184, v104, s[48:49]
    v_cndmask_b32 v185, v185, v105, s[50:51]
    v_mul_f32 v184, v184, v186
    v_mul_f32 v185, v185, v187
    v_cvt_pk_bf16_f32 v222, v184, v185
    s_add_u32 s63, s62, 133632
    buffer_store_dword v222, v9, s[20:23], s63 offen sc1
    v_min_f32 v188, s43, v140
    v_min_f32 v189, s43, v141
    v_exp_f32 v142, v142
    v_exp_f32 v143, v143
    v_exp_f32 v188, v188
    v_exp_f32 v189, v189
    v_cmp_gt_f32 s[48:49], s42, abs(v140)
    v_cmp_gt_f32 s[50:51], s42, abs(v141)
    v_add_f32 v190, 1.0, v188
    v_add_f32 v191, 1.0, v189
    v_mul_f32 v140, s46, v140
    v_mul_f32 v141, s46, v141
    v_fmac_f32 v190, v190, v142
    v_fmac_f32 v191, v191, v143
    v_sub_f32 v188, 1.0, v188
    v_sub_f32 v189, 1.0, v189
    v_rcp_f32 v190, v190
    v_rcp_f32 v191, v191
    v_cndmask_b32 v188, v188, v140, s[48:49]
    v_cndmask_b32 v189, v189, v141, s[50:51]
    v_mul_f32 v188, v188, v190
    v_mul_f32 v189, v189, v191
    v_cvt_pk_bf16_f32 v223, v188, v189
    s_add_u32 s63, s62, 138240
    buffer_store_dword v223, v9, s[20:23], s63 offen sc1
    v_min_f32 v184, s43, v72
    v_min_f32 v185, s43, v73
    v_exp_f32 v74, v74
    v_exp_f32 v75, v75
    v_exp_f32 v184, v184
    v_exp_f32 v185, v185
    v_cmp_gt_f32 s[48:49], s42, abs(v72)
    v_cmp_gt_f32 s[50:51], s42, abs(v73)
    v_add_f32 v186, 1.0, v184
    v_add_f32 v187, 1.0, v185
    v_mul_f32 v72, s46, v72
    v_mul_f32 v73, s46, v73
    v_fmac_f32 v186, v186, v74
    v_fmac_f32 v187, v187, v75
    v_sub_f32 v184, 1.0, v184
    v_sub_f32 v185, 1.0, v185
    v_rcp_f32 v186, v186
    v_rcp_f32 v187, v187
    v_cndmask_b32 v184, v184, v72, s[48:49]
    v_cndmask_b32 v185, v185, v73, s[50:51]
    v_mul_f32 v184, v184, v186
    v_mul_f32 v185, v185, v187
    v_cvt_pk_bf16_f32 v224, v184, v185
    s_add_u32 s63, s62, 147456
    buffer_store_dword v224, v9, s[20:23], s63 offen sc1
    v_min_f32 v188, s43, v108
    v_min_f32 v189, s43, v109
    v_exp_f32 v110, v110
    v_exp_f32 v111, v111
    v_exp_f32 v188, v188
    v_exp_f32 v189, v189
    v_cmp_gt_f32 s[48:49], s42, abs(v108)
    v_cmp_gt_f32 s[50:51], s42, abs(v109)
    v_add_f32 v190, 1.0, v188
    v_add_f32 v191, 1.0, v189
    v_mul_f32 v108, s46, v108
    v_mul_f32 v109, s46, v109
    v_fmac_f32 v190, v190, v110
    v_fmac_f32 v191, v191, v111
    v_sub_f32 v188, 1.0, v188
    v_sub_f32 v189, 1.0, v189
    v_rcp_f32 v190, v190
    v_rcp_f32 v191, v191
    v_cndmask_b32 v188, v188, v108, s[48:49]
    v_cndmask_b32 v189, v189, v109, s[50:51]
    v_mul_f32 v188, v188, v190
    v_mul_f32 v189, v189, v191
    v_cvt_pk_bf16_f32 v225, v188, v189
    s_add_u32 s63, s62, 152064
    buffer_store_dword v225, v9, s[20:23], s63 offen sc1
    v_min_f32 v184, s43, v144
    v_min_f32 v185, s43, v145
    v_exp_f32 v146, v146
    v_exp_f32 v147, v147
    v_exp_f32 v184, v184
    v_exp_f32 v185, v185
    v_cmp_gt_f32 s[48:49], s42, abs(v144)
    v_cmp_gt_f32 s[50:51], s42, abs(v145)
    v_add_f32 v186, 1.0, v184
    v_add_f32 v187, 1.0, v185
    v_mul_f32 v144, s46, v144
    v_mul_f32 v145, s46, v145
    v_fmac_f32 v186, v186, v146
    v_fmac_f32 v187, v187, v147
    v_sub_f32 v184, 1.0, v184
    v_sub_f32 v185, 1.0, v185
    v_rcp_f32 v186, v186
    v_rcp_f32 v187, v187
    v_cndmask_b32 v184, v184, v144, s[48:49]
    v_cndmask_b32 v185, v185, v145, s[50:51]
    v_mul_f32 v184, v184, v186
    v_mul_f32 v185, v185, v187
    v_cvt_pk_bf16_f32 v226, v184, v185
    s_add_u32 s63, s62, 156672
    buffer_store_dword v226, v9, s[20:23], s63 offen sc1
L_fin:
    s_setprio 0
    s_load_dwordx2 s[6:7], s[0:1], 24
    v_and_b32 v2, 63, v0
    v_lshlrev_b32 v3, 4, v2
    v_lshlrev_b32 v4, 2, v2
    v_add_u32 v6, 4096, v4
    v_mov_b32 v37, 0
    s_lshr_b32 s40, s28, 1
    s_and_b32 s41, s28, 1
    s_lshr_b32 s42, s26, 2
    s_lshl_b32 s43, s40, 2
    s_lshl_b32 s44, s42, 1
    s_add_u32 s43, s43, s44
    s_add_u32 s43, s43, s41
    s_mul_i32 s43, s43, 9
    s_add_u32 s43, s43, s29
    s_lshl_b32 s43, s43, 2
    s_add_u32 s43, s43, s24
    s_mul_i32 s46, s43, 4608
    s_add_u32 s46, s46, 21030912
    s_cmp_ge_u32 s40, 7
    s_cselect_b32 s37, 4608000, 0
    s_cselect_b32 s36, 7, 0
    s_sub_u32 s32, s40, s36
    s_lshl_b32 s32, s32, 1
    s_add_u32 s32, s32, s41
    s_mul_i32 s32, s32, 144
    s_add_u32 s32, s32, s29
    s_mul_i32 s33, s26, 18
    s_add_u32 s32, s32, s33
    s_mul_i32 s45, s32, 2304
    s_waitcnt lgkmcnt(0)
    s_add_u32 s6, s6, s37
    s_addc_u32 s7, s7, 0
    s_mov_b32 s16, s6
    s_and_b32 s17, s7, 0xffff
    s_mov_b32 s18, 4608000
    s_mov_b32 s19, 0x00020000
    s_lshl_b32 s47, s24, 1
    s_sub_u32 s47, s42, s47
    s_add_u32 s47, s47, 6
    s_mul_i32 s47, s47, 288
    s_add_u32 s47, s47, 53248
    v_lshrrev_b32 v7, 4, v2
    v_mul_u32_u24 v7, 9216, v7
    v_add_u32 v7, s47, v7
    v_and_b32 v8, 15, v2
    v_lshl_add_u32 v11, v8, 1, v7
    v_lshl_add_u32 v10, v8, 4, v7
    s_mul_i32 s48, s26, 4608
    s_add_u32 s48, s48, 53248
    v_add_u32 v12, s48, v3
    v_add_u32 v13, s45, v3
    v_add_u32 v14, 18432, v13
    v_cmp_gt_u32 vcc, 16, v2
    v_cmp_gt_u32 s[48:49], 32, v2
    v_add_u32 v36, 4096, v14
    v_mov_b32 v5, 2130706432
    v_cndmask_b32 v15, v14, v13, vcc
    v_cndmask_b32 v36, v5, v36, s[48:49]
    v_mov_b32 v34, 0
    v_mov_b32 v35, 0
    s_mul_i32 s30, s41, 9
    s_add_u32 s30, s30, s29
    s_lshl_b32 s30, s30, 3
    s_lshl_b32 s50, s40, 8
    s_add_u32 s50, s50, 30342400
    s_add_u32 s30, s30, s50
    v_min_u32 v5, 17, v2
    v_lshlrev_b32 v5, 3, v5
    s_mov_b32 s51, 0
    s_waitcnt vmcnt(0)
    s_barrier
    s_cmp_lg_u32 s26, 4
    s_cbranch_scc1 L_e1b
    v_mov_b32 v38, s92
    v_mov_b32 v39, s93
    s_mov_b64 exec, 1
    buffer_store_dwordx2 v[38:39], v37, s[20:23], s30 offen sc1
    s_mov_b64 exec, -1
L_e1b:
    ds_read_b128 v[76:79], v3 offset:0
    ds_read_b128 v[80:83], v3 offset:1024
    ds_read_b128 v[84:87], v3 offset:2048
    ds_read_b128 v[88:91], v3 offset:3072
    ds_read_b128 v[92:95], v3 offset:4096
    ds_read_b128 v[96:99], v3 offset:5120
    ds_read_b128 v[100:103], v3 offset:6144
    ds_read_b128 v[104:107], v3 offset:7168
    ds_read_b128 v[108:111], v3 offset:8192
    ds_read_b128 v[112:115], v3 offset:9216
    ds_read_b128 v[116:119], v3 offset:10240
    ds_read_b128 v[120:123], v3 offset:11264
    s_waitcnt lgkmcnt(4)
    ds_read_b128 v[124:127], v3 offset:12288
    ds_read_b128 v[128:131], v3 offset:13312
    ds_read_b128 v[132:135], v3 offset:14336
    ds_read_b128 v[136:139], v3 offset:15360
    ds_read_b128 v[140:143], v3 offset:16384
    ds_read_b128 v[144:147], v3 offset:17408
    ds_read_b128 v[148:151], v3 offset:18432
    ds_read_b128 v[152:155], v3 offset:19456
    ds_read_b128 v[156:159], v3 offset:20480
    ds_read_b128 v[160:163], v3 offset:21504
    ds_read_b128 v[164:167], v3 offset:22528
    ds_read_b128 v[168:171], v3 offset:23552
    s_waitcnt lgkmcnt(4)
    ds_read_b128 v[172:175], v3 offset:24576
    ds_read_b128 v[176:179], v3 offset:25600
    ds_read_b128 v[180:183], v3 offset:26624
    ds_read_b128 v[184:187], v3 offset:27648
    ds_read_b128 v[188:191], v3 offset:28672
    ds_read_b128 v[192:195], v3 offset:29696
    ds_read_b128 v[196:199], v3 offset:30720
    ds_read_b128 v[200:203], v3 offset:31744
    ds_read_b128 v[204:207], v3 offset:32768
    ds_read_b128 v[208:211], v3 offset:33792
    ds_read_b128 v[212:215], v3 offset:34816
    ds_read_b128 v[216:219], v3 offset:35840
    s_waitcnt lgkmcnt(4)
    ds_read_b128 v[220:223], v3 offset:36864
    ds_read_b128 v[224:227], v3 offset:37888
    ds_read_b128 v[228:231], v3 offset:38912
    ds_read_b128 v[232:235], v3 offset:39936
    ds_read_b128 v[236:239], v3 offset:40960
    ds_read_b128 v[240:243], v3 offset:41984
    ds_read_b128 v[244:247], v3 offset:43008
    ds_read_b128 v[248:251], v3 offset:44032
    ds_read_b128 v[252:255], v3 offset:45056
    s_cmp_lg_u32 s26, 4
    s_cbranch_scc1 L_e2
L_zpoll:
    buffer_load_dwordx2 v[8:9], v5, s[20:23], s50 offen sc1
    s_add_u32 s51, s51, 1
    s_cmp_gt_u32 s51, 400000
    s_cbranch_scc1 L_e2
    s_waitcnt vmcnt(0)
    v_cmp_ne_u64 vcc, s[92:93], v[8:9]
    s_cbranch_vccz L_e2
    s_sleep 1
    s_branch L_zpoll
L_e2:
    s_barrier
    buffer_load_dword v16, v4, s[20:23], s46 offen offset:0 sc1
    buffer_load_dword v17, v4, s[20:23], s46 offen offset:256 sc1
    buffer_load_dword v18, v4, s[20:23], s46 offen offset:512 sc1
    buffer_load_dword v19, v4, s[20:23], s46 offen offset:768 sc1
    buffer_load_dword v20, v4, s[20:23], s46 offen offset:1024 sc1
    buffer_load_dword v21, v4, s[20:23], s46 offen offset:1280 sc1
    buffer_load_dword v22, v4, s[20:23], s46 offen offset:1536 sc1
    buffer_load_dword v23, v4, s[20:23], s46 offen offset:1792 sc1
    buffer_load_dword v24, v4, s[20:23], s46 offen offset:2048 sc1
    buffer_load_dword v25, v4, s[20:23], s46 offen offset:2304 sc1
    buffer_load_dword v26, v4, s[20:23], s46 offen offset:2560 sc1
    buffer_load_dword v27, v4, s[20:23], s46 offen offset:2816 sc1
    buffer_load_dword v28, v4, s[20:23], s46 offen offset:3072 sc1
    buffer_load_dword v29, v4, s[20:23], s46 offen offset:3328 sc1
    buffer_load_dword v30, v4, s[20:23], s46 offen offset:3584 sc1
    buffer_load_dword v31, v4, s[20:23], s46 offen offset:3840 sc1
    buffer_load_dword v32, v6, s[20:23], s46 offen offset:0 sc1
    buffer_load_dword v33, v6, s[20:23], s46 offen offset:256 sc1
    s_waitcnt lgkmcnt(0)
    s_waitcnt vmcnt(14)
    v_mfma_f32_16x16x32_bf16 v[40:43], v[16:19], v[76:79], 0
    v_mfma_f32_16x16x32_bf16 v[44:47], v[16:19], v[96:99], 0
    v_mfma_f32_16x16x32_bf16 v[48:51], v[16:19], v[116:119], 0
    v_mfma_f32_16x16x32_bf16 v[52:55], v[16:19], v[136:139], 0
    v_mfma_f32_16x16x32_bf16 v[56:59], v[16:19], v[156:159], 0
    v_mfma_f32_16x16x32_bf16 v[60:63], v[16:19], v[176:179], 0
    v_mfma_f32_16x16x32_bf16 v[64:67], v[16:19], v[196:199], 0
    v_mfma_f32_16x16x32_bf16 v[68:71], v[16:19], v[216:219], 0
    v_mfma_f32_16x16x32_bf16 v[72:75], v[16:19], v[236:239], 0
    s_waitcnt vmcnt(10)
    v_mfma_f32_16x16x32_bf16 v[40:43], v[20:23], v[80:83], v[40:43]
    v_mfma_f32_16x16x32_bf16 v[44:47], v[20:23], v[100:103], v[44:47]
    v_mfma_f32_16x16x32_bf16 v[48:51], v[20:23], v[120:123], v[48:51]
    v_mfma_f32_16x16x32_bf16 v[52:55], v[20:23], v[140:143], v[52:55]
    v_mfma_f32_16x16x32_bf16 v[56:59], v[20:23], v[160:163], v[56:59]
    v_mfma_f32_16x16x32_bf16 v[60:63], v[20:23], v[180:183], v[60:63]
    v_mfma_f32_16x16x32_bf16 v[64:67], v[20:23], v[200:203], v[64:67]
    v_mfma_f32_16x16x32_bf16 v[68:71], v[20:23], v[220:223], v[68:71]
    v_mfma_f32_16x16x32_bf16 v[72:75], v[20:23], v[240:243], v[72:75]
    s_waitcnt vmcnt(6)
    v_mfma_f32_16x16x32_bf16 v[40:43], v[24:27], v[84:87], v[40:43]
    v_mfma_f32_16x16x32_bf16 v[44:47], v[24:27], v[104:107], v[44:47]
    v_mfma_f32_16x16x32_bf16 v[48:51], v[24:27], v[124:127], v[48:51]
    v_mfma_f32_16x16x32_bf16 v[52:55], v[24:27], v[144:147], v[52:55]
    v_mfma_f32_16x16x32_bf16 v[56:59], v[24:27], v[164:167], v[56:59]
    v_mfma_f32_16x16x32_bf16 v[60:63], v[24:27], v[184:187], v[60:63]
    v_mfma_f32_16x16x32_bf16 v[64:67], v[24:27], v[204:207], v[64:67]
    v_mfma_f32_16x16x32_bf16 v[68:71], v[24:27], v[224:227], v[68:71]
    v_mfma_f32_16x16x32_bf16 v[72:75], v[24:27], v[244:247], v[72:75]
    s_waitcnt vmcnt(2)
    v_mfma_f32_16x16x32_bf16 v[40:43], v[28:31], v[88:91], v[40:43]
    v_mfma_f32_16x16x32_bf16 v[44:47], v[28:31], v[108:111], v[44:47]
    v_mfma_f32_16x16x32_bf16 v[48:51], v[28:31], v[128:131], v[48:51]
    v_mfma_f32_16x16x32_bf16 v[52:55], v[28:31], v[148:151], v[52:55]
    v_mfma_f32_16x16x32_bf16 v[56:59], v[28:31], v[168:171], v[56:59]
    v_mfma_f32_16x16x32_bf16 v[60:63], v[28:31], v[188:191], v[60:63]
    v_mfma_f32_16x16x32_bf16 v[64:67], v[28:31], v[208:211], v[64:67]
    v_mfma_f32_16x16x32_bf16 v[68:71], v[28:31], v[228:231], v[68:71]
    v_mfma_f32_16x16x32_bf16 v[72:75], v[28:31], v[248:251], v[72:75]
    s_waitcnt vmcnt(0)
    v_mfma_f32_16x16x32_bf16 v[40:43], v[32:35], v[92:95], v[40:43]
    v_mfma_f32_16x16x32_bf16 v[44:47], v[32:35], v[112:115], v[44:47]
    v_mfma_f32_16x16x32_bf16 v[48:51], v[32:35], v[132:135], v[48:51]
    v_mfma_f32_16x16x32_bf16 v[52:55], v[32:35], v[152:155], v[52:55]
    v_mfma_f32_16x16x32_bf16 v[56:59], v[32:35], v[172:175], v[56:59]
    v_mfma_f32_16x16x32_bf16 v[60:63], v[32:35], v[192:195], v[60:63]
    v_mfma_f32_16x16x32_bf16 v[64:67], v[32:35], v[212:215], v[64:67]
    v_mfma_f32_16x16x32_bf16 v[68:71], v[32:35], v[232:235], v[68:71]
    v_mfma_f32_16x16x32_bf16 v[72:75], v[32:35], v[252:255], v[72:75]
    s_nop 7
    s_nop 1
    v_cvt_pk_bf16_f32 v140, v40, v44
    v_cvt_pk_bf16_f32 v141, v48, v52
    v_cvt_pk_bf16_f32 v142, v56, v60
    v_cvt_pk_bf16_f32 v143, v64, v68
    v_cvt_pk_bf16_f32 v144, v72, v72
    ds_write_b128 v10, v[140:143] offset:0
    ds_write_b16 v11, v144 offset:256
    v_cvt_pk_bf16_f32 v146, v41, v45
    v_cvt_pk_bf16_f32 v147, v49, v53
    v_cvt_pk_bf16_f32 v148, v57, v61
    v_cvt_pk_bf16_f32 v149, v65, v69
    v_cvt_pk_bf16_f32 v150, v73, v73
    ds_write_b128 v10, v[146:149] offset:2304
    ds_write_b16 v11, v150 offset:2560
    v_cvt_pk_bf16_f32 v152, v42, v46
    v_cvt_pk_bf16_f32 v153, v50, v54
    v_cvt_pk_bf16_f32 v154, v58, v62
    v_cvt_pk_bf16_f32 v155, v66, v70
    v_cvt_pk_bf16_f32 v156, v74, v74
    ds_write_b128 v10, v[152:155] offset:4608
    ds_write_b16 v11, v156 offset:4864
    v_cvt_pk_bf16_f32 v158, v43, v47
    v_cvt_pk_bf16_f32 v159, v51, v55
    v_cvt_pk_bf16_f32 v160, v59, v63
    v_cvt_pk_bf16_f32 v161, v67, v71
    v_cvt_pk_bf16_f32 v162, v75, v75
    ds_write_b128 v10, v[158:161] offset:6912
    ds_write_b16 v11, v162 offset:7168
    s_waitcnt lgkmcnt(0)
    s_barrier
    ds_read_b128 v[76:79], v12 offset:0
    ds_read_b128 v[80:83], v12 offset:1024
    ds_read_b128 v[84:87], v12 offset:2048
    ds_read_b128 v[88:91], v12 offset:3072
    ds_read_b128 v[92:95], v12 offset:4096
    s_waitcnt lgkmcnt(4)
    buffer_store_dwordx4 v[76:79], v13, s[16:19], 0 offen offset:0 sc1
    s_waitcnt lgkmcnt(3)
    buffer_store_dwordx4 v[80:83], v13, s[16:19], 0 offen offset:1024 sc1
    s_waitcnt lgkmcnt(2)
    buffer_store_dwordx4 v[84:87], v15, s[16:19], 0 offen offset:2048 sc1
    s_waitcnt lgkmcnt(1)
    buffer_store_dwordx4 v[88:91], v14, s[16:19], 0 offen offset:3072 sc1
    s_waitcnt lgkmcnt(0)
    buffer_store_dwordx4 v[92:95], v36, s[16:19], 0 offen offset:0 sc1
L_end:
    s_endpgm

.section .rodata,"a"
.p2align 6
.amdhsa_kernel standalone__autoregressive_conv_wavenet__speech_kernel
  .amdhsa_next_free_vgpr 256
  .amdhsa_next_free_sgpr 100
  .amdhsa_accum_offset 256
  .amdhsa_group_segment_fixed_size 0
  .amdhsa_kernarg_size 48
  .amdhsa_user_sgpr_count 2
  .amdhsa_user_sgpr_kernarg_segment_ptr 1
  .amdhsa_system_sgpr_workgroup_id_x 1
.end_amdhsa_kernel
```
